```python
import torch

def _softmax(x, axis=-1):
    return torch.softmax(x, dim=axis)

def _gelu(x):
    return torch.nn.functional.gelu(x, approximate='tanh')

def _silu(x):
    return torch.nn.functional.silu(x)

def _sigmoid(x):
    return torch.sigmoid(x)

def _layernorm(x, axis=-1, eps=1e-05):
    m = x.mean(dim=axis, keepdim=True)
    v = x.var(dim=axis, keepdim=True, unbiased=False)
    return (x - m) / torch.sqrt(v + eps)

def _scatter_add(tgt, idx, src, axis=0):
    return tgt.clone().index_add_(axis, idx, src)

def _segment_sum(src, seg, n):
    out = torch.zeros((n,) + src.shape[1:], dtype=src.dtype)
    return out.index_add_(0, seg, src)

def _pad(x, pw):
    flat = tuple((v for pair in reversed(pw) for v in pair))
    return torch.nn.functional.pad(x, flat)
kernel_name = 'standalone__conformer_family_branchformer__speech'

def setup_inputs():

    _w = lambda a: (lambda t: t.to(torch.bfloat16) if t.is_floating_point() else t)(torch.as_tensor(a))
    B, T, D, K = (2, 4000, 144, 15)
    s = float(D) ** (-0.5)
    return {'x': _w((lambda *s: torch.randn(*s, dtype=torch.bfloat16) * 0.05)(B, T, D)), 'w_q': _w((lambda *s: torch.randn(*s, dtype=torch.bfloat16) * 1.6)(D, D) * s), 'w_k': _w((lambda *s: torch.randn(*s, dtype=torch.bfloat16) * 1.6)(D, D) * s), 'w_v': _w((lambda *s: torch.randn(*s, dtype=torch.bfloat16) * 0.4)(D, D) * s), 'w_ao': _w((lambda *s: torch.randn(*s, dtype=torch.bfloat16) * 0.4)(D, D) * s), 'w_up': _w((lambda *s: torch.randn(*s, dtype=torch.bfloat16) * 0.8)(D, 2 * D) * s), 'dw': _w((lambda *s: torch.randn(*s, dtype=torch.bfloat16) * 0.8)(K, D) * (1.0 / K)), 'w_dn': _w((lambda *s: torch.randn(*s, dtype=torch.bfloat16) * 0.4)(D, D) * s), 'w_merge': _w((lambda *s: torch.randn(*s, dtype=torch.bfloat16) * 0.4)(2 * D, D) * s)}

def reference(x, w_q, w_k, w_v, w_ao, w_up, dw, w_dn, w_merge):
    B, T, D = x.shape
    K = dw.shape[0]
    xa = _layernorm(x, axis=-1)
    q = torch.einsum('btd,de->bte', xa, w_q)
    k = torch.einsum('btd,de->bte', xa, w_k)
    v = torch.einsum('btd,de->bte', xa, w_v)
    logits = torch.einsum('btd,bsd->bts', q, k) * float(D) ** (-0.5)
    attn = _softmax(logits, axis=-1)
    ya = torch.einsum('bts,bsd->btd', attn, v)
    ya = torch.einsum('btd,de->bte', ya, w_ao)
    xc = _layernorm(x, axis=-1)
    h = _gelu(torch.einsum('btd,de->bte', xc, w_up))
    u = h[..., :D].clone()
    g = _layernorm(h[..., D:], axis=-1)
    pad = K // 2
    gp = _pad(g, ((0, 0), (pad, pad), (0, 0)))
    conv = torch.zeros_like(g)
    for i in range(K):
        conv = conv + gp[:, i:i + T, :] * dw[i][None, None, :]
    yc = torch.einsum('btd,de->bte', u * conv, w_dn)
    merged = torch.concatenate([ya, yc], axis=-1)
    out = torch.einsum('btf,fd->btd', merged, w_merge)
    return x + out
```

```asm
; @launch grid=(256,1,1) block=(256,1,1) lds=163840
.amdgcn_target "amdgcn-amd-amdhsa--gfx950"
.text
.globl standalone__conformer_family_branchformer__speech_kernel
.p2align 8
.type standalone__conformer_family_branchformer__speech_kernel,@function
standalone__conformer_family_branchformer__speech_kernel:
    s_cmp_ge_u32 s2, 256
    s_cbranch_scc1 K_END
    s_load_dwordx2 s[56:57], s[0:1], 8
    s_load_dwordx2 s[40:41], s[0:1], 0
    s_load_dwordx2 s[8:9], s[0:1], 88
    s_load_dwordx2 s[52:53], s[0:1], 80
    s_load_dwordx2 s[60:61], s[0:1], 16
    s_getpc_b64 s[66:67]
K_PC:
    v_lshlrev_b32 v16, 7, v0
    v_min_u32 v16, K_LAST-K_PC, v16
    v_mov_b32 v17, s67
    v_add_co_u32 v16, vcc, s66, v16
    s_nop 1
    v_addc_co_u32 v17, vcc, 0, v17, vcc
    global_load_dword a255, v[16:17], off
    v_lshrrev_b32 v1, 6, v0
    s_and_b32 s3, s2, 7
    s_and_b32 s16, s3, 1
    s_bfe_u32 s17, s2, 0x10003
    s_lshr_b32 s18, s2, 4
    s_lshl_b32 s18, s18, 2
    s_lshr_b32 s3, s3, 1
    s_add_u32 s18, s18, s3
    v_readfirstlane_b32 s19, v1
    v_and_b32 v0, 63, v0
    v_lshlrev_b32 v1, 4, v0
    v_add_u32 v2, 4096, v1
    v_add_u32 v3, 8192, v1
    s_lshl_b32 s23, s18, 1
    s_add_u32 s23, s23, s17
    s_cmp_eq_u32 s18, 63
    s_cbranch_scc1 K_SPARE
    s_lshl_b32 s3, s18, 6
    s_lshl_b32 s21, s19, 4
    s_add_u32 s27, s3, s21
    s_mul_i32 s3, s16, 1152000
    s_mul_i32 s26, s27, 288
    s_mul_i32 m0, s19, 5120
    s_mov_b32 s42, 1152000
    s_mov_b32 s43, 0x00020000
    s_waitcnt lgkmcnt(0)
    s_add_u32 s40, s40, s3
    s_addc_u32 s41, s41, 0
    buffer_load_dwordx4 v1, s[40:43], s26 offen offset:0 lds
    buffer_load_dwordx4 v1, s[40:43], s26 offen offset:1024 lds
    buffer_load_dwordx4 v1, s[40:43], s26 offen offset:2048 lds
    buffer_load_dwordx4 v1, s[40:43], s26 offen offset:3072 lds
    s_add_u32 m0, m0, 4096
    s_add_u32 s26, s26, 4096
    buffer_load_dwordx4 v1, s[40:43], s26 offen lds
    s_lshr_b32 s24, s2, 3
    s_mov_b32 s58, 41472
    s_mov_b32 s59, 0x00020000
    s_mov_b32 s62, 41472
    s_mov_b32 s63, 0x00020000
    s_mul_i32 s3, s24, 11
    s_mul_i32 s21, s19, 3
    s_add_u32 s3, s3, s21
    v_add_u32 v12, s3, v0
    v_lshlrev_b32 v12, 7, v12
    v_mov_b32 v14, 0x7fffffff
    v_cmp_gt_u32 vcc, 3, v0
    s_nop 1
    v_cndmask_b32 v12, v14, v12, vcc
    buffer_load_dword a250, v12, s[56:59], 0 offen
    buffer_load_dword a251, v12, s[60:63], 0 offen
    s_mov_b32 s54, 256
    s_mov_b32 s55, 0x00020000
    s_and_b32 s3, s2, 31
    s_add_u32 s3, s3, s19
    s_cmp_lg_u32 s3, 0
    s_cbranch_scc1 K_NOCAND
    s_memrealtime s[66:67]
    v_mov_b32 v40, 0
    s_waitcnt lgkmcnt(0)
    s_or_b32 s66, s66, 1
    v_mov_b32 v42, s66
    v_mov_b32 v43, 0
    s_mov_b64 exec, 1
    buffer_atomic_cmpswap v[42:43], v40, s[52:55], 0 offen sc1
    s_mov_b64 exec, -1
K_NOCAND:
    v_lshrrev_b32 v12, 2, v0
    v_mul_u32_u24 v13, 288, v12
    v_and_b32 v14, 3, v0
    v_lshl_add_u32 v13, v14, 4, v13
    v_and_b32 v12, 8, v12
    v_sub_u32 v90, v13, v12
    s_mul_i32 s26, s24, 9
    s_lshr_b32 s26, s26, 5
    v_and_b32 v9, 15, v0
    v_lshrrev_b32 v10, 4, v0
    s_lshl_b32 s3, s18, 6
    s_lshl_b32 s21, s19, 4
    s_add_u32 s3, s3, s21
    v_add_u32 v11, s3, v9
    s_add_u32 s27, s26, s19
    s_sub_u32 s3, s27, 9
    s_cmp_ge_u32 s27, 9
    s_cselect_b32 s27, s3, s27
    s_mul_i32 s84, s27, 4608
    s_mul_i32 s85, s27, 5120
    s_add_u32 s85, s85, 40960
    s_add_u32 m0, s85, 0
    s_nop 0
    buffer_load_dwordx4 v90, s[56:59], s84 offen offset:0 lds
    s_mov_b32 s10, 33554432
    s_mov_b32 s11, 0x00020000
    s_mov_b32 s46, 2304000
    s_mov_b32 s47, 0x00020000
    s_load_dwordx2 s[44:45], s[0:1], 72
    s_add_u32 s27, s27, 4
    s_sub_u32 s3, s27, 9
    s_cmp_ge_u32 s27, 9
    s_cselect_b32 s27, s3, s27
    s_mul_i32 s86, s27, 4608
    s_mul_i32 s87, s27, 5120
    s_add_u32 s87, s87, 40960
    s_add_u32 s27, s26, 8
    s_sub_u32 s3, s27, 9
    s_cmp_ge_u32 s27, 9
    s_cselect_b32 s27, s3, s27
    s_mul_i32 s88, s27, 4608
    s_mul_i32 s89, s27, 5120
    s_add_u32 s89, s89, 40960
    s_lshl_b32 s3, s19, 6
    s_add_u32 s3, s3, 64
    s_add_u32 s31, s88, s3
    s_lshl_b32 s3, s3, 4
    s_add_u32 s30, s89, s3
    s_and_b32 s3, s19, 1
    s_lshl_b32 s73, s3, 10
    s_mul_i32 s3, s16, 1280000
    s_add_u32 s4, s8, s3
    s_addc_u32 s5, s9, 0
    s_mov_b32 s6, 1280000
    s_mov_b32 s7, 0x00020000
    s_lshr_b32 s25, s19, 1
    v_and_b32 v12, 31, v0
    v_lshrrev_b32 v13, 5, v0
    v_bfe_u32 v14, v0, 2, 2
    v_xor_b32 v14, v13, v14
    v_mul_u32_u24 v4, 320, v12
    v_lshl_add_u32 v4, v14, 4, v4
    v_xor_b32 v5, 32, v4
    v_and_b32 v14, 1, v10
    v_lshlrev_b32 v14, 1, v14
    v_lshrrev_b32 v12, 1, v10
    v_or_b32 v12, v12, v14
    v_bfe_u32 v14, v0, 2, 2
    v_lshl_add_u32 v14, v12, 2, v14
    v_mul_u32_u24 v6, 320, v14
    v_bfe_u32 v14, v0, 1, 1
    v_xor_b32 v14, v14, v12
    v_lshl_add_u32 v6, v14, 4, v6
    v_and_b32 v14, 1, v0
    v_lshl_add_u32 v6, v14, 3, v6
    v_xor_b32 v7, 32, v6
    v_bfe_u32 v12, v0, 2, 2
    v_and_b32 v13, 3, v0
    v_and_b32 v14, 1, v10
    v_lshl_add_u32 v12, v14, 3, v12
    v_lshlrev_b32 v12, 6, v12
    v_lshl_add_u32 v12, v14, 3, v12
    v_add_u32 v12, 40960, v12
    v_lshl_add_u32 v92, v13, 4, v12
    v_lshl_add_u32 v94, v13, 3, v12
    v_lshrrev_b32 v14, 1, v10
    v_mul_u32_u24 v14, 5120, v14
    v_add_u32 v91, v92, v14
    v_add_u32 v93, v94, v14
    v_and_b32 v12, 1, v10
    v_lshl_add_u32 v12, v12, 2, v13
    v_cmp_eq_u32 vcc, 7, v12
    v_mov_b32 v12, 8
    v_mov_b32 v13, 968
    v_cndmask_b32 v12, v12, v13, vcc
    v_add_u32 v95, v91, v12
    v_add_u32 v89, v92, v12
    v_mul_u32_u24 v14, 288, v9
    v_lshl_add_u32 v45, v10, 3, v14
    v_add_u32 v45, 87296, v45
    v_lshl_add_u32 v44, v10, 4, v14
    v_add_u32 v44, 87040, v44
    s_lshl_b32 s3, s19, 4
    v_add_u32 v46, s3, v9
    v_mul_u32_u24 v46, 304, v46
    v_lshl_add_u32 v46, v10, 3, v46
    v_add_u32 v46, 129024, v46
    s_lshl_b32 s3, s17, 6
    s_lshl_b32 s21, s19, 4
    s_add_u32 s27, s3, s21
    v_lshrrev_b32 v12, 1, v0
    v_add_u32 v12, s27, v12
    s_mov_b32 s3, 125
    v_cmp_gt_u32 s[28:29], s3, v12
    s_nop 1
    s_and_b64 s[38:39], s[28:29], 0xffffffff
    s_and_b64 s[28:29], s[28:29], 0x3f
    s_lshl_b32 s3, s16, 7
    v_add_u32 v12, s3, v12
    v_lshlrev_b32 v12, 6, v12
    v_and_b32 v13, 1, v0
    v_lshl_add_u32 v12, v13, 2, v12
    v_add_u32 v47, 8388608, v12
    v_accvgpr_write_b32 a200, v44
    v_accvgpr_write_b32 a201, v45
    v_accvgpr_write_b32 a202, v46
    v_accvgpr_write_b32 a203, v47
    v_bfe_u32 v12, v0, 2, 2
    v_xor_b32 v12, v12, v10
    v_mul_u32_u24 v13, 320, v11
    v_lshl_add_u32 v8, v12, 4, v13
    v_cmp_eq_u32 s[32:33], 2, v10
    s_lshl_b32 s3, s16, 7
    s_add_u32 s3, s3, s23
    s_lshl_b32 s3, s3, 6
    s_and_b32 s21, s19, 1
    s_lshl_b32 s21, s21, 2
    s_add_u32 s3, s3, s21
    s_add_u32 s34, s3, 8388608
    s_lshl_b32 s3, s17, 2
    s_add_u32 s3, s3, s19
    s_mul_i32 s12, s3, 163840
    s_mul_i32 s13, s19, 10240
    s_add_u32 s14, s13, 40960
    s_add_u32 s15, s13, 81920
    s_lshr_b32 s3, s2, 4
    s_mul_i32 s3, s3, 15
    v_add_u32 v13, s3, v0
    v_lshlrev_b32 v13, 7, v13
    v_add_u32 v13, s12, v13
    v_mov_b32 v14, 0x7fffffff
    v_cmp_gt_u32 vcc, 15, v0
    s_nop 1
    v_cndmask_b32 v13, v14, v13, vcc
    v_accvgpr_write_b32 a204, v13
    v_mov_b32 v80, 0
    v_mov_b32 v81, 0
    v_mov_b32 v82, 0
    v_mov_b32 v83, 0
    s_nop 1
    v_mfma_f32_32x32x16_bf16 v[96:111], v[80:83], v[80:83], 0
    v_mfma_f32_32x32x16_bf16 v[112:127], v[80:83], v[80:83], 0
    v_mfma_f32_32x32x16_bf16 v[128:143], v[80:83], v[80:83], 0
    v_mfma_f32_32x32x16_bf16 v[144:159], v[80:83], v[80:83], 0
    v_mfma_f32_32x32x16_bf16 v[160:175], v[80:83], v[80:83], 0
    v_mfma_f32_32x32x16_bf16 v[176:191], v[80:83], v[80:83], 0
    v_mfma_f32_32x32x16_bf16 v[192:207], v[80:83], v[80:83], 0
    v_mfma_f32_32x32x16_bf16 v[208:223], v[80:83], v[80:83], 0
    v_mfma_f32_32x32x16_bf16 v[224:239], v[80:83], v[80:83], 0
    v_mfma_f32_32x32x16_bf16 v[240:255], v[80:83], v[80:83], 0
    v_mov_b32 v36, 0x3f803f80
    v_mov_b32 v37, 0x3f803f80
    v_mov_b32 v38, 0x3f803f80
    v_mov_b32 v39, 0x3f803f80
    s_mov_b32 s90, 0x22222222
    s_mov_b32 s91, 0x22222222
    s_mov_b32 s92, 0x44444444
    s_mov_b32 s93, 0x44444444
    s_mov_b32 s94, 0x88888888
    s_mov_b32 s95, 0x88888888
    s_mov_b32 s96, 0x00f0000f
    s_mov_b32 s97, 0xf0000f00
    v_cmp_gt_u32 s[98:99], 2, v10
    v_mov_b32 v15, 0
    v_mul_u32_u24 v12, 288, v9
    v_lshl_add_u32 v12, v10, 4, v12
    s_mul_i32 s3, s19, 5120
    v_add_u32 v12, s3, v12
    s_waitcnt vmcnt(3)
    ds_read_b128 v[16:19], v12 offset:0
    ds_read_b128 v[20:23], v12 offset:64
    ds_read_b128 v[24:27], v12 offset:128
    ds_read_b128 v[28:31], v12 offset:192
    ds_read_b128 v[32:35], v12 offset:256
    s_add_u32 m0, s85, 960
    s_nop 0
    buffer_load_dwordx4 v90, s[56:59], s84 offen offset:64 lds
    s_waitcnt lgkmcnt(0)
    v_cndmask_b32 v32, 0, v32, s[98:99]
    v_cndmask_b32 v33, 0, v33, s[98:99]
    v_cndmask_b32 v34, 0, v34, s[98:99]
    v_cndmask_b32 v35, 0, v35, s[98:99]
    v_mfma_f32_16x16x32_bf16 v[80:83], v[36:39], v[16:19], 0
    v_mfma_f32_16x16x32_bf16 v[84:87], v[16:19], v[16:19], 0
    v_lshlrev_b32 v40, 16, v16
    v_and_b32 v41, 0xffff0000, v16
    v_lshlrev_b32 v42, 16, v17
    v_and_b32 v43, 0xffff0000, v17
    s_add_u32 m0, s85, 1920
    s_nop 0
    buffer_load_dwordx4 v90, s[56:59], s84 offen offset:128 lds
    v_mfma_f32_16x16x32_bf16 v[80:83], v[36:39], v[20:23], v[80:83]
    v_mfma_f32_16x16x32_bf16 v[84:87], v[20:23], v[20:23], v[84:87]
    v_lshlrev_b32 v48, 16, v20
    v_and_b32 v49, 0xffff0000, v20
    v_lshlrev_b32 v50, 16, v21
    v_and_b32 v51, 0xffff0000, v21
    v_mfma_f32_16x16x32_bf16 v[80:83], v[36:39], v[24:27], v[80:83]
    v_mfma_f32_16x16x32_bf16 v[84:87], v[24:27], v[24:27], v[84:87]
    v_lshlrev_b32 v56, 16, v24
    v_and_b32 v57, 0xffff0000, v24
    v_lshlrev_b32 v58, 16, v25
    s_add_u32 m0, s85, 2880
    s_nop 0
    buffer_load_dwordx4 v90, s[56:59], s84 offen offset:192 lds
    v_and_b32 v59, 0xffff0000, v25
    v_mfma_f32_16x16x32_bf16 v[80:83], v[36:39], v[28:31], v[80:83]
    v_mfma_f32_16x16x32_bf16 v[84:87], v[28:31], v[28:31], v[84:87]
    v_lshlrev_b32 v64, 16, v28
    v_and_b32 v65, 0xffff0000, v28
    v_lshlrev_b32 v66, 16, v29
    v_and_b32 v67, 0xffff0000, v29
    v_mfma_f32_16x16x32_bf16 v[80:83], v[36:39], v[32:35], v[80:83]
    v_mfma_f32_16x16x32_bf16 v[84:87], v[32:35], v[32:35], v[84:87]
    v_lshlrev_b32 v72, 16, v32
    v_and_b32 v73, 0xffff0000, v32
    s_add_u32 m0, s85, 3840
    s_nop 0
    buffer_load_dwordx4 v90, s[56:59], s84 offen offset:256 lds
    v_lshlrev_b32 v74, 16, v33
    v_and_b32 v75, 0xffff0000, v33
    v_lshlrev_b32 v44, 16, v18
    v_and_b32 v45, 0xffff0000, v18
    v_lshlrev_b32 v46, 16, v19
    v_and_b32 v47, 0xffff0000, v19
    v_lshlrev_b32 v52, 16, v22
    v_and_b32 v53, 0xffff0000, v22
    v_lshlrev_b32 v54, 16, v23
    v_and_b32 v55, 0xffff0000, v23
    v_lshlrev_b32 v60, 16, v26
    s_add_u32 m0, s87, 0
    s_nop 0
    buffer_load_dwordx4 v90, s[56:59], s86 offen offset:0 lds
    v_and_b32 v61, 0xffff0000, v26
    v_lshlrev_b32 v62, 16, v27
    v_and_b32 v63, 0xffff0000, v27
    v_lshlrev_b32 v68, 16, v30
    v_and_b32 v69, 0xffff0000, v30
    v_lshlrev_b32 v70, 16, v31
    v_and_b32 v71, 0xffff0000, v31
    v_lshlrev_b32 v76, 16, v34
    v_and_b32 v77, 0xffff0000, v34
    v_lshlrev_b32 v78, 16, v35
    v_and_b32 v79, 0xffff0000, v35
    s_add_u32 m0, s87, 960
    s_nop 0
    buffer_load_dwordx4 v90, s[56:59], s86 offen offset:64 lds
    v_cndmask_b32 v84, v84, v85, s[90:91]
    v_cndmask_b32 v84, v84, v86, s[92:93]
    v_cndmask_b32 v84, v84, v87, s[94:95]
    v_cndmask_b32 v84, 0, v84, s[96:97]
    v_mul_f32 v80, 0x3be38e39, v80
    v_mov_b32 v85, v84
    s_nop 1
    v_permlane16_swap_b32 v84, v85
    v_add_f32 v84, v84, v85
    v_mov_b32 v85, v84
    s_nop 1
    v_permlane32_swap_b32 v84, v85
    v_add_f32 v84, v84, v85
    s_add_u32 m0, s87, 1920
    s_nop 0
    buffer_load_dwordx4 v90, s[56:59], s86 offen offset:128 lds
    v_mul_f32 v81, v80, v80
    v_mov_b32 v82, 0x3be38e39
    v_fma_f32 v81, v84, v82, -v81
    v_max_f32 v81, 0, v81
    v_add_f32 v81, 0x3727c5ac, v81
    v_rsq_f32 v81, v81
    s_nop 0
    v_mul_f32 v82, v80, v81
    v_sub_f32 v82, 0, v82
    v_cndmask_b32 v83, 0, v82, s[98:99]
    v_fma_f32 v40, v40, v81, v82
    s_add_u32 m0, s87, 2880
    s_nop 0
    buffer_load_dwordx4 v90, s[56:59], s86 offen offset:192 lds
    v_fma_f32 v41, v41, v81, v82
    v_fma_f32 v42, v42, v81, v82
    v_fma_f32 v43, v43, v81, v82
    v_cvt_pk_bf16_f32 v16, v40, v41
    v_fma_f32 v44, v44, v81, v82
    v_fma_f32 v45, v45, v81, v82
    v_cvt_pk_bf16_f32 v17, v42, v43
    v_fma_f32 v46, v46, v81, v82
    v_fma_f32 v47, v47, v81, v82
    v_cvt_pk_bf16_f32 v18, v44, v45
    v_fma_f32 v48, v48, v81, v82
    s_add_u32 m0, s87, 3840
    s_nop 0
    buffer_load_dwordx4 v90, s[56:59], s86 offen offset:256 lds
    v_fma_f32 v49, v49, v81, v82
    v_cvt_pk_bf16_f32 v19, v46, v47
    v_fma_f32 v50, v50, v81, v82
    v_fma_f32 v51, v51, v81, v82
    v_cvt_pk_bf16_f32 v20, v48, v49
    v_fma_f32 v52, v52, v81, v82
    v_fma_f32 v53, v53, v81, v82
    v_cvt_pk_bf16_f32 v21, v50, v51
    v_fma_f32 v54, v54, v81, v82
    v_fma_f32 v55, v55, v81, v82
    v_cvt_pk_bf16_f32 v22, v52, v53
    s_add_u32 m0, s89, 0
    s_nop 0
    buffer_load_dwordx4 v90, s[56:59], s88 offen offset:0 lds
    v_fma_f32 v56, v56, v81, v82
    v_fma_f32 v57, v57, v81, v82
    v_cvt_pk_bf16_f32 v23, v54, v55
    v_fma_f32 v58, v58, v81, v82
    v_fma_f32 v59, v59, v81, v82
    v_cvt_pk_bf16_f32 v24, v56, v57
    v_fma_f32 v60, v60, v81, v82
    v_fma_f32 v61, v61, v81, v82
    v_cvt_pk_bf16_f32 v25, v58, v59
    v_fma_f32 v62, v62, v81, v82
    v_fma_f32 v63, v63, v81, v82
    s_mov_b32 m0, s30
    s_nop 0
    buffer_load_dwordx4 v90, s[56:59], s31 offen lds
    v_cvt_pk_bf16_f32 v26, v60, v61
    v_fma_f32 v64, v64, v81, v82
    v_fma_f32 v65, v65, v81, v82
    v_cvt_pk_bf16_f32 v27, v62, v63
    v_fma_f32 v66, v66, v81, v82
    v_fma_f32 v67, v67, v81, v82
    v_cvt_pk_bf16_f32 v28, v64, v65
    v_fma_f32 v68, v68, v81, v82
    v_fma_f32 v69, v69, v81, v82
    v_cvt_pk_bf16_f32 v29, v66, v67
    v_fma_f32 v70, v70, v81, v82
    buffer_load_dword v88, v15, s[52:55], 0 offen sc1
    v_fma_f32 v71, v71, v81, v82
    v_cvt_pk_bf16_f32 v30, v68, v69
    v_fma_f32 v72, v72, v81, v83
    v_fma_f32 v73, v73, v81, v83
    v_cvt_pk_bf16_f32 v31, v70, v71
    v_fma_f32 v74, v74, v81, v83
    v_fma_f32 v75, v75, v81, v83
    v_cvt_pk_bf16_f32 v32, v72, v73
    v_fma_f32 v76, v76, v81, v83
    v_fma_f32 v77, v77, v81, v83
    v_cvt_pk_bf16_f32 v33, v74, v75
    v_fma_f32 v78, v78, v81, v83
    v_fma_f32 v79, v79, v81, v83
    v_cvt_pk_bf16_f32 v34, v76, v77
    v_cvt_pk_bf16_f32 v35, v78, v79
    s_cmp_lg_u32 s25, s17
    s_cbranch_scc1 K_NOPUB
    v_mov_b32 v36, v32
    v_mov_b32 v37, v33
    v_mov_b32 v38, v34
    v_mov_b32 v39, v35
    v_mov_b32 v13, 0x3f80
    v_cndmask_b32 v36, v36, v13, s[32:33]
    buffer_store_dwordx4 v[16:19], v8, s[4:7], 0 offen offset:0 sc1
    buffer_store_dwordx4 v[20:23], v8, s[4:7], 0 offen offset:64 sc1
    buffer_store_dwordx4 v[24:27], v8, s[4:7], 0 offen offset:128 sc1
    buffer_store_dwordx4 v[28:31], v8, s[4:7], 0 offen offset:192 sc1
    buffer_store_dwordx4 v[36:39], v8, s[4:7], 0 offen offset:256 sc1
    v_accvgpr_read_b32 v44, a200
    v_accvgpr_read_b32 v45, a201
    v_accvgpr_read_b32 v46, a202
    v_accvgpr_read_b32 v47, a203
    s_waitcnt vmcnt(6)
    s_barrier
    ds_read_b64_tr_b16 a[72:73], v91 offset:0
    ds_read_b64_tr_b16 a[74:75], v91 offset:256
    ds_read_b64_tr_b16 a[76:77], v91 offset:10240
    ds_read_b64_tr_b16 a[78:79], v91 offset:10496
    ds_read_b64_tr_b16 a[80:81], v91 offset:20480
    ds_read_b64_tr_b16 a[82:83], v91 offset:20736
    ds_read_b64_tr_b16 a[84:85], v91 offset:30720
    ds_read_b64_tr_b16 a[86:87], v91 offset:30976
    ds_read_b64_tr_b16 a[88:89], v92 offset:40960
    ds_read_b64_tr_b16 a[90:91], v92 offset:41216
    ds_read_b64_tr_b16 a[92:93], v95 offset:0
    ds_read_b64_tr_b16 a[94:95], v95 offset:256
    ds_read_b64_tr_b16 a[96:97], v95 offset:10240
    ds_read_b64_tr_b16 a[98:99], v95 offset:10496
    ds_read_b64_tr_b16 a[100:101], v95 offset:20480
    ds_read_b64_tr_b16 a[102:103], v95 offset:20736
    ds_read_b64_tr_b16 a[104:105], v95 offset:30720
    ds_read_b64_tr_b16 a[106:107], v95 offset:30976
    ds_read_b64_tr_b16 a[108:109], v89 offset:40960
    ds_read_b64_tr_b16 a[110:111], v89 offset:41216
    s_waitcnt lgkmcnt(15)
    v_mfma_f32_16x16x32_bf16 v[80:83], a[72:75], v[16:19], 0
    ds_read_b64_tr_b16 a[112:113], v91 offset:1024
    ds_read_b64_tr_b16 a[114:115], v91 offset:1280
    v_mfma_f32_16x16x32_bf16 v[80:83], a[76:79], v[20:23], v[80:83]
    ds_read_b64_tr_b16 a[116:117], v91 offset:11264
    ds_read_b64_tr_b16 a[118:119], v91 offset:11520
    s_waitcnt lgkmcnt(15)
    v_mfma_f32_16x16x32_bf16 v[80:83], a[80:83], v[24:27], v[80:83]
    ds_read_b64_tr_b16 a[120:121], v91 offset:21504
    ds_read_b64_tr_b16 a[122:123], v91 offset:21760
    v_mfma_f32_16x16x32_bf16 v[80:83], a[84:87], v[28:31], v[80:83]
    ds_read_b64_tr_b16 a[124:125], v91 offset:31744
    ds_read_b64_tr_b16 a[126:127], v91 offset:32000
    s_waitcnt lgkmcnt(15)
    v_mfma_f32_16x16x32_bf16 v[80:83], a[88:91], v[32:35], v[80:83]
    ds_read_b64_tr_b16 a[128:129], v92 offset:41984
    ds_read_b64_tr_b16 a[130:131], v92 offset:42240
    v_mfma_f32_16x16x32_bf16 v[84:87], a[92:95], v[16:19], 0
    ds_read_b64_tr_b16 a[72:73], v95 offset:1024
    ds_read_b64_tr_b16 a[74:75], v95 offset:1280
    s_waitcnt lgkmcnt(15)
    v_mfma_f32_16x16x32_bf16 v[84:87], a[96:99], v[20:23], v[84:87]
    ds_read_b64_tr_b16 a[76:77], v95 offset:11264
    ds_read_b64_tr_b16 a[78:79], v95 offset:11520
    v_mfma_f32_16x16x32_bf16 v[84:87], a[100:103], v[24:27], v[84:87]
    ds_read_b64_tr_b16 a[80:81], v95 offset:21504
    ds_read_b64_tr_b16 a[82:83], v95 offset:21760
    v_cvt_pk_bf16_f32 v56, v80, v81
    v_cvt_pk_bf16_f32 v57, v82, v83
    s_waitcnt lgkmcnt(15)
    v_mfma_f32_16x16x32_bf16 v[84:87], a[104:107], v[28:31], v[84:87]
    ds_read_b64_tr_b16 a[84:85], v95 offset:31744
    ds_read_b64_tr_b16 a[86:87], v95 offset:32000
    v_mfma_f32_16x16x32_bf16 v[84:87], a[108:111], v[32:35], v[84:87]
    ds_read_b64_tr_b16 a[88:89], v89 offset:41984
    ds_read_b64_tr_b16 a[90:91], v89 offset:42240
    s_waitcnt lgkmcnt(15)
    v_mfma_f32_16x16x32_bf16 v[80:83], a[112:115], v[16:19], 0
    ds_read_b64_tr_b16 a[92:93], v91 offset:2048
    ds_read_b64_tr_b16 a[94:95], v91 offset:2304
    v_mfma_f32_16x16x32_bf16 v[80:83], a[116:119], v[20:23], v[80:83]
    ds_read_b64_tr_b16 a[96:97], v91 offset:12288
    ds_read_b64_tr_b16 a[98:99], v91 offset:12544
    s_waitcnt lgkmcnt(15)
    v_mfma_f32_16x16x32_bf16 v[80:83], a[120:123], v[24:27], v[80:83]
    ds_read_b64_tr_b16 a[100:101], v91 offset:22528
    ds_read_b64_tr_b16 a[102:103], v91 offset:22784
    v_cvt_pk_bf16_f32 v58, v84, v85
    v_cvt_pk_bf16_f32 v59, v86, v87
    v_mfma_f32_16x16x32_bf16 v[80:83], a[124:127], v[28:31], v[80:83]
    ds_read_b64_tr_b16 a[104:105], v91 offset:32768
    ds_read_b64_tr_b16 a[106:107], v91 offset:33024
    s_waitcnt lgkmcnt(15)
    v_mfma_f32_16x16x32_bf16 v[80:83], a[128:131], v[32:35], v[80:83]
    ds_read_b64_tr_b16 a[108:109], v92 offset:43008
    ds_read_b64_tr_b16 a[110:111], v92 offset:43264
    v_mfma_f32_16x16x32_bf16 v[84:87], a[72:75], v[16:19], 0
    ds_read_b64_tr_b16 a[112:113], v95 offset:2048
    ds_read_b64_tr_b16 a[114:115], v95 offset:2304
    s_waitcnt lgkmcnt(15)
    v_mfma_f32_16x16x32_bf16 v[84:87], a[76:79], v[20:23], v[84:87]
    ds_read_b64_tr_b16 a[116:117], v95 offset:12288
    ds_read_b64_tr_b16 a[118:119], v95 offset:12544
    v_mfma_f32_16x16x32_bf16 v[84:87], a[80:83], v[24:27], v[84:87]
    ds_read_b64_tr_b16 a[120:121], v95 offset:22528
    ds_read_b64_tr_b16 a[122:123], v95 offset:22784
    v_cvt_pk_bf16_f32 v60, v80, v81
    v_cvt_pk_bf16_f32 v61, v82, v83
    s_waitcnt lgkmcnt(15)
    v_mfma_f32_16x16x32_bf16 v[84:87], a[84:87], v[28:31], v[84:87]
    ds_read_b64_tr_b16 a[124:125], v95 offset:32768
    ds_read_b64_tr_b16 a[126:127], v95 offset:33024
    v_mfma_f32_16x16x32_bf16 v[84:87], a[88:91], v[32:35], v[84:87]
    ds_read_b64_tr_b16 a[128:129], v89 offset:43008
    ds_read_b64_tr_b16 a[130:131], v89 offset:43264
    s_waitcnt vmcnt(5)
    v_readfirstlane_b32 s64, v88
    s_nop 1
    s_cmp_lg_u32 s64, 0
    s_cbranch_scc1 K_GOTNP
    v_mov_b32 v15, 0
    s_mov_b32 s65, 0
POLL1:
    buffer_load_dword v88, v15, s[52:55], 0 offen sc1
POLLC1:
    s_waitcnt vmcnt(0)
    v_cmp_eq_u32 vcc, 0, v88
    s_add_u32 s65, s65, 1
    s_nop 3
    s_cbranch_vccz POLLD1
    s_sleep 1
    s_cmp_lt_u32 s65, 65536
    s_cbranch_scc1 POLL1
POLLD1:
    v_readfirstlane_b32 s64, v88
K_GOTNP:
    v_mov_b32 v13, s34
    s_nop 0
    v_mov_b32 v12, s64
    s_mov_b64 exec, 1
    s_waitcnt vmcnt(0)
    buffer_store_dword v12, v13, s[8:11], 0 offen sc1
    s_mov_b64 exec, -1
    s_waitcnt lgkmcnt(15)
    v_mfma_f32_16x16x32_bf16 v[80:83], a[92:95], v[16:19], 0
    ds_read_b64_tr_b16 a[72:73], v91 offset:3072
    ds_read_b64_tr_b16 a[74:75], v91 offset:3328
    v_mfma_f32_16x16x32_bf16 v[80:83], a[96:99], v[20:23], v[80:83]
    ds_read_b64_tr_b16 a[76:77], v91 offset:13312
    ds_read_b64_tr_b16 a[78:79], v91 offset:13568
    s_waitcnt lgkmcnt(15)
    v_mfma_f32_16x16x32_bf16 v[80:83], a[100:103], v[24:27], v[80:83]
    ds_read_b64_tr_b16 a[80:81], v91 offset:23552
    ds_read_b64_tr_b16 a[82:83], v91 offset:23808
    v_cvt_pk_bf16_f32 v62, v84, v85
    v_cvt_pk_bf16_f32 v63, v86, v87
    v_mfma_f32_16x16x32_bf16 v[80:83], a[104:107], v[28:31], v[80:83]
    ds_read_b64_tr_b16 a[84:85], v91 offset:33792
    ds_read_b64_tr_b16 a[86:87], v91 offset:34048
    s_waitcnt lgkmcnt(15)
    v_mfma_f32_16x16x32_bf16 v[80:83], a[108:111], v[32:35], v[80:83]
    ds_read_b64_tr_b16 a[88:89], v92 offset:44032
    ds_read_b64_tr_b16 a[90:91], v92 offset:44288
    v_mfma_f32_16x16x32_bf16 v[84:87], a[112:115], v[16:19], 0
    ds_read_b64_tr_b16 a[92:93], v95 offset:3072
    ds_read_b64_tr_b16 a[94:95], v95 offset:3328
    s_waitcnt lgkmcnt(15)
    v_mfma_f32_16x16x32_bf16 v[84:87], a[116:119], v[20:23], v[84:87]
    ds_read_b64_tr_b16 a[96:97], v95 offset:13312
    ds_read_b64_tr_b16 a[98:99], v95 offset:13568
    v_mfma_f32_16x16x32_bf16 v[84:87], a[120:123], v[24:27], v[84:87]
    ds_read_b64_tr_b16 a[100:101], v95 offset:23552
    ds_read_b64_tr_b16 a[102:103], v95 offset:23808
    v_cvt_pk_bf16_f32 v64, v80, v81
    v_cvt_pk_bf16_f32 v65, v82, v83
    s_waitcnt lgkmcnt(15)
    v_mfma_f32_16x16x32_bf16 v[84:87], a[124:127], v[28:31], v[84:87]
    ds_read_b64_tr_b16 a[104:105], v95 offset:33792
    ds_read_b64_tr_b16 a[106:107], v95 offset:34048
    v_mfma_f32_16x16x32_bf16 v[84:87], a[128:131], v[32:35], v[84:87]
    ds_read_b64_tr_b16 a[108:109], v89 offset:44032
    ds_read_b64_tr_b16 a[110:111], v89 offset:44288
    s_waitcnt lgkmcnt(15)
    v_mfma_f32_16x16x32_bf16 v[80:83], a[72:75], v[16:19], 0
    ds_read_b64_tr_b16 a[112:113], v93 offset:4096
    ds_read_b64_tr_b16 a[114:115], v93 offset:4352
    v_mfma_f32_16x16x32_bf16 v[80:83], a[76:79], v[20:23], v[80:83]
    ds_read_b64_tr_b16 a[116:117], v93 offset:14336
    ds_read_b64_tr_b16 a[118:119], v93 offset:14592
    s_waitcnt lgkmcnt(15)
    v_mfma_f32_16x16x32_bf16 v[80:83], a[80:83], v[24:27], v[80:83]
    ds_read_b64_tr_b16 a[120:121], v93 offset:24576
    ds_read_b64_tr_b16 a[122:123], v93 offset:24832
    v_cvt_pk_bf16_f32 v66, v84, v85
    v_cvt_pk_bf16_f32 v67, v86, v87
    v_mfma_f32_16x16x32_bf16 v[80:83], a[84:87], v[28:31], v[80:83]
    ds_read_b64_tr_b16 a[124:125], v93 offset:34816
    ds_read_b64_tr_b16 a[126:127], v93 offset:35072
    s_waitcnt lgkmcnt(15)
    v_mfma_f32_16x16x32_bf16 v[80:83], a[88:91], v[32:35], v[80:83]
    ds_read_b64_tr_b16 a[128:129], v94 offset:45056
    ds_read_b64_tr_b16 a[130:131], v94 offset:45312
    v_mfma_f32_16x16x32_bf16 v[84:87], a[92:95], v[16:19], 0
    s_waitcnt lgkmcnt(15)
    v_mfma_f32_16x16x32_bf16 v[84:87], a[96:99], v[20:23], v[84:87]
    s_waitcnt lgkmcnt(14)
    v_mfma_f32_16x16x32_bf16 v[84:87], a[100:103], v[24:27], v[84:87]
    s_nop 0
    v_cvt_pk_bf16_f32 v68, v80, v81
    v_cvt_pk_bf16_f32 v69, v82, v83
    s_waitcnt lgkmcnt(12)
    v_mfma_f32_16x16x32_bf16 v[84:87], a[104:107], v[28:31], v[84:87]
    s_waitcnt lgkmcnt(10)
    v_mfma_f32_16x16x32_bf16 v[84:87], a[108:111], v[32:35], v[84:87]
    s_waitcnt lgkmcnt(8)
    v_mfma_f32_16x16x32_bf16 v[80:83], a[112:115], v[16:19], 0
    s_waitcnt lgkmcnt(6)
    v_mfma_f32_16x16x32_bf16 v[80:83], a[116:119], v[20:23], v[80:83]
    s_waitcnt lgkmcnt(4)
    v_mfma_f32_16x16x32_bf16 v[80:83], a[120:123], v[24:27], v[80:83]
    s_nop 1
    v_cvt_pk_bf16_f32 v70, v84, v85
    v_cvt_pk_bf16_f32 v71, v86, v87
    s_waitcnt lgkmcnt(2)
    v_mfma_f32_16x16x32_bf16 v[80:83], a[124:127], v[28:31], v[80:83]
    s_waitcnt lgkmcnt(0)
    v_mfma_f32_16x16x32_bf16 v[80:83], a[128:131], v[32:35], v[80:83]
    s_branch K_PUBD
K_NOPUB:
    v_accvgpr_read_b32 v44, a200
    v_accvgpr_read_b32 v45, a201
    v_accvgpr_read_b32 v46, a202
    v_accvgpr_read_b32 v47, a203
    s_add_u32 m0, s73, 87040
    s_add_u32 s74, s73, 0
    buffer_load_dwordx4 v1, s[60:63], s74 offen offset:0 lds
    buffer_load_dwordx4 v1, s[60:63], s74 offen offset:2048 lds
    s_add_u32 m0, s73, 91136
    s_add_u32 s74, s73, 4096
    buffer_load_dwordx4 v1, s[60:63], s74 offen offset:0 lds
    buffer_load_dwordx4 v1, s[60:63], s74 offen offset:2048 lds
    s_add_u32 m0, s73, 95232
    s_add_u32 s74, s73, 8192
    buffer_load_dwordx4 v1, s[60:63], s74 offen offset:0 lds
    s_waitcnt vmcnt(6)
    s_barrier
    ds_read_b64_tr_b16 a[72:73], v91 offset:0
    ds_read_b64_tr_b16 a[74:75], v91 offset:256
    ds_read_b64_tr_b16 a[76:77], v91 offset:10240
    ds_read_b64_tr_b16 a[78:79], v91 offset:10496
    ds_read_b64_tr_b16 a[80:81], v91 offset:20480
    ds_read_b64_tr_b16 a[82:83], v91 offset:20736
    ds_read_b64_tr_b16 a[84:85], v91 offset:30720
    ds_read_b64_tr_b16 a[86:87], v91 offset:30976
    ds_read_b64_tr_b16 a[88:89], v92 offset:40960
    ds_read_b64_tr_b16 a[90:91], v92 offset:41216
    ds_read_b64_tr_b16 a[92:93], v95 offset:0
    ds_read_b64_tr_b16 a[94:95], v95 offset:256
    ds_read_b64_tr_b16 a[96:97], v95 offset:10240
    ds_read_b64_tr_b16 a[98:99], v95 offset:10496
    ds_read_b64_tr_b16 a[100:101], v95 offset:20480
    ds_read_b64_tr_b16 a[102:103], v95 offset:20736
    ds_read_b64_tr_b16 a[104:105], v95 offset:30720
    ds_read_b64_tr_b16 a[106:107], v95 offset:30976
    ds_read_b64_tr_b16 a[108:109], v89 offset:40960
    ds_read_b64_tr_b16 a[110:111], v89 offset:41216
    s_waitcnt lgkmcnt(15)
    v_mfma_f32_16x16x32_bf16 v[80:83], a[72:75], v[16:19], 0
    ds_read_b64_tr_b16 a[112:113], v91 offset:1024
    ds_read_b64_tr_b16 a[114:115], v91 offset:1280
    v_mfma_f32_16x16x32_bf16 v[80:83], a[76:79], v[20:23], v[80:83]
    ds_read_b64_tr_b16 a[116:117], v91 offset:11264
    ds_read_b64_tr_b16 a[118:119], v91 offset:11520
    buffer_load_dwordx4 v1, s[60:63], s74 offen offset:2048 lds
    s_waitcnt lgkmcnt(15)
    v_mfma_f32_16x16x32_bf16 v[80:83], a[80:83], v[24:27], v[80:83]
    ds_read_b64_tr_b16 a[120:121], v91 offset:21504
    ds_read_b64_tr_b16 a[122:123], v91 offset:21760
    v_mfma_f32_16x16x32_bf16 v[80:83], a[84:87], v[28:31], v[80:83]
    ds_read_b64_tr_b16 a[124:125], v91 offset:31744
    ds_read_b64_tr_b16 a[126:127], v91 offset:32000
    s_add_u32 m0, s73, 99328
    s_add_u32 s74, s73, 12288
    buffer_load_dwordx4 v1, s[60:63], s74 offen offset:0 lds
    s_waitcnt lgkmcnt(15)
    v_mfma_f32_16x16x32_bf16 v[80:83], a[88:91], v[32:35], v[80:83]
    ds_read_b64_tr_b16 a[128:129], v92 offset:41984
    ds_read_b64_tr_b16 a[130:131], v92 offset:42240
    v_mfma_f32_16x16x32_bf16 v[84:87], a[92:95], v[16:19], 0
    ds_read_b64_tr_b16 a[72:73], v95 offset:1024
    ds_read_b64_tr_b16 a[74:75], v95 offset:1280
    s_waitcnt lgkmcnt(15)
    v_mfma_f32_16x16x32_bf16 v[84:87], a[96:99], v[20:23], v[84:87]
    ds_read_b64_tr_b16 a[76:77], v95 offset:11264
    ds_read_b64_tr_b16 a[78:79], v95 offset:11520
    buffer_load_dwordx4 v1, s[60:63], s74 offen offset:2048 lds
    v_mfma_f32_16x16x32_bf16 v[84:87], a[100:103], v[24:27], v[84:87]
    ds_read_b64_tr_b16 a[80:81], v95 offset:21504
    ds_read_b64_tr_b16 a[82:83], v95 offset:21760
    v_cvt_pk_bf16_f32 v56, v80, v81
    v_cvt_pk_bf16_f32 v57, v82, v83
    s_waitcnt lgkmcnt(15)
    v_mfma_f32_16x16x32_bf16 v[84:87], a[104:107], v[28:31], v[84:87]
    ds_read_b64_tr_b16 a[84:85], v95 offset:31744
    ds_read_b64_tr_b16 a[86:87], v95 offset:32000
    s_add_u32 m0, s73, 103424
    s_add_u32 s74, s73, 16384
    buffer_load_dwordx4 v1, s[60:63], s74 offen offset:0 lds
    v_mfma_f32_16x16x32_bf16 v[84:87], a[108:111], v[32:35], v[84:87]
    ds_read_b64_tr_b16 a[88:89], v89 offset:41984
    ds_read_b64_tr_b16 a[90:91], v89 offset:42240
    s_waitcnt lgkmcnt(15)
    v_mfma_f32_16x16x32_bf16 v[80:83], a[112:115], v[16:19], 0
    ds_read_b64_tr_b16 a[92:93], v91 offset:2048
    ds_read_b64_tr_b16 a[94:95], v91 offset:2304
    v_mfma_f32_16x16x32_bf16 v[80:83], a[116:119], v[20:23], v[80:83]
    ds_read_b64_tr_b16 a[96:97], v91 offset:12288
    ds_read_b64_tr_b16 a[98:99], v91 offset:12544
    buffer_load_dwordx4 v1, s[60:63], s74 offen offset:2048 lds
    s_waitcnt lgkmcnt(15)
    v_mfma_f32_16x16x32_bf16 v[80:83], a[120:123], v[24:27], v[80:83]
    ds_read_b64_tr_b16 a[100:101], v91 offset:22528
    ds_read_b64_tr_b16 a[102:103], v91 offset:22784
    v_cvt_pk_bf16_f32 v58, v84, v85
    v_cvt_pk_bf16_f32 v59, v86, v87
    v_mfma_f32_16x16x32_bf16 v[80:83], a[124:127], v[28:31], v[80:83]
    ds_read_b64_tr_b16 a[104:105], v91 offset:32768
    ds_read_b64_tr_b16 a[106:107], v91 offset:33024
    s_add_u32 m0, s73, 107520
    s_add_u32 s74, s73, 20480
    buffer_load_dwordx4 v1, s[60:63], s74 offen offset:0 lds
    s_waitcnt lgkmcnt(15)
    v_mfma_f32_16x16x32_bf16 v[80:83], a[128:131], v[32:35], v[80:83]
    ds_read_b64_tr_b16 a[108:109], v92 offset:43008
    ds_read_b64_tr_b16 a[110:111], v92 offset:43264
    v_mfma_f32_16x16x32_bf16 v[84:87], a[72:75], v[16:19], 0
    ds_read_b64_tr_b16 a[112:113], v95 offset:2048
    ds_read_b64_tr_b16 a[114:115], v95 offset:2304
    s_waitcnt lgkmcnt(15)
    v_mfma_f32_16x16x32_bf16 v[84:87], a[76:79], v[20:23], v[84:87]
    ds_read_b64_tr_b16 a[116:117], v95 offset:12288
    ds_read_b64_tr_b16 a[118:119], v95 offset:12544
    buffer_load_dwordx4 v1, s[60:63], s74 offen offset:2048 lds
    v_mfma_f32_16x16x32_bf16 v[84:87], a[80:83], v[24:27], v[84:87]
    ds_read_b64_tr_b16 a[120:121], v95 offset:22528
    ds_read_b64_tr_b16 a[122:123], v95 offset:22784
    v_cvt_pk_bf16_f32 v60, v80, v81
    v_cvt_pk_bf16_f32 v61, v82, v83
    s_waitcnt lgkmcnt(15)
    v_mfma_f32_16x16x32_bf16 v[84:87], a[84:87], v[28:31], v[84:87]
    ds_read_b64_tr_b16 a[124:125], v95 offset:32768
    ds_read_b64_tr_b16 a[126:127], v95 offset:33024
    s_add_u32 m0, s73, 111616
    s_add_u32 s74, s73, 24576
    buffer_load_dwordx4 v1, s[60:63], s74 offen offset:0 lds
    v_mfma_f32_16x16x32_bf16 v[84:87], a[88:91], v[32:35], v[84:87]
    ds_read_b64_tr_b16 a[128:129], v89 offset:43008
    ds_read_b64_tr_b16 a[130:131], v89 offset:43264
    s_waitcnt lgkmcnt(15)
    v_mfma_f32_16x16x32_bf16 v[80:83], a[92:95], v[16:19], 0
    ds_read_b64_tr_b16 a[72:73], v91 offset:3072
    ds_read_b64_tr_b16 a[74:75], v91 offset:3328
    v_mfma_f32_16x16x32_bf16 v[80:83], a[96:99], v[20:23], v[80:83]
    ds_read_b64_tr_b16 a[76:77], v91 offset:13312
    ds_read_b64_tr_b16 a[78:79], v91 offset:13568
    buffer_load_dwordx4 v1, s[60:63], s74 offen offset:2048 lds
    s_waitcnt lgkmcnt(15)
    v_mfma_f32_16x16x32_bf16 v[80:83], a[100:103], v[24:27], v[80:83]
    ds_read_b64_tr_b16 a[80:81], v91 offset:23552
    ds_read_b64_tr_b16 a[82:83], v91 offset:23808
    v_cvt_pk_bf16_f32 v62, v84, v85
    v_cvt_pk_bf16_f32 v63, v86, v87
    v_mfma_f32_16x16x32_bf16 v[80:83], a[104:107], v[28:31], v[80:83]
    ds_read_b64_tr_b16 a[84:85], v91 offset:33792
    ds_read_b64_tr_b16 a[86:87], v91 offset:34048
    s_add_u32 m0, s73, 115712
    s_add_u32 s74, s73, 28672
    buffer_load_dwordx4 v1, s[60:63], s74 offen offset:0 lds
    s_waitcnt lgkmcnt(15)
    v_mfma_f32_16x16x32_bf16 v[80:83], a[108:111], v[32:35], v[80:83]
    ds_read_b64_tr_b16 a[88:89], v92 offset:44032
    ds_read_b64_tr_b16 a[90:91], v92 offset:44288
    v_mfma_f32_16x16x32_bf16 v[84:87], a[112:115], v[16:19], 0
    ds_read_b64_tr_b16 a[92:93], v95 offset:3072
    ds_read_b64_tr_b16 a[94:95], v95 offset:3328
    s_waitcnt lgkmcnt(15)
    v_mfma_f32_16x16x32_bf16 v[84:87], a[116:119], v[20:23], v[84:87]
    ds_read_b64_tr_b16 a[96:97], v95 offset:13312
    ds_read_b64_tr_b16 a[98:99], v95 offset:13568
    buffer_load_dwordx4 v1, s[60:63], s74 offen offset:2048 lds
    v_mfma_f32_16x16x32_bf16 v[84:87], a[120:123], v[24:27], v[84:87]
    ds_read_b64_tr_b16 a[100:101], v95 offset:23552
    ds_read_b64_tr_b16 a[102:103], v95 offset:23808
    v_cvt_pk_bf16_f32 v64, v80, v81
    v_cvt_pk_bf16_f32 v65, v82, v83
    s_waitcnt lgkmcnt(15)
    v_mfma_f32_16x16x32_bf16 v[84:87], a[124:127], v[28:31], v[84:87]
    ds_read_b64_tr_b16 a[104:105], v95 offset:33792
    ds_read_b64_tr_b16 a[106:107], v95 offset:34048
    s_add_u32 m0, s73, 119808
    s_add_u32 s74, s73, 32768
    buffer_load_dwordx4 v1, s[60:63], s74 offen offset:0 lds
    v_mfma_f32_16x16x32_bf16 v[84:87], a[128:131], v[32:35], v[84:87]
    ds_read_b64_tr_b16 a[108:109], v89 offset:44032
    ds_read_b64_tr_b16 a[110:111], v89 offset:44288
    s_waitcnt lgkmcnt(15)
    v_mfma_f32_16x16x32_bf16 v[80:83], a[72:75], v[16:19], 0
    ds_read_b64_tr_b16 a[112:113], v93 offset:4096
    ds_read_b64_tr_b16 a[114:115], v93 offset:4352
    v_mfma_f32_16x16x32_bf16 v[80:83], a[76:79], v[20:23], v[80:83]
    ds_read_b64_tr_b16 a[116:117], v93 offset:14336
    ds_read_b64_tr_b16 a[118:119], v93 offset:14592
    buffer_load_dwordx4 v1, s[60:63], s74 offen offset:2048 lds
    s_waitcnt lgkmcnt(15)
    v_mfma_f32_16x16x32_bf16 v[80:83], a[80:83], v[24:27], v[80:83]
    ds_read_b64_tr_b16 a[120:121], v93 offset:24576
    ds_read_b64_tr_b16 a[122:123], v93 offset:24832
    v_cvt_pk_bf16_f32 v66, v84, v85
    v_cvt_pk_bf16_f32 v67, v86, v87
    v_mfma_f32_16x16x32_bf16 v[80:83], a[84:87], v[28:31], v[80:83]
    ds_read_b64_tr_b16 a[124:125], v93 offset:34816
    ds_read_b64_tr_b16 a[126:127], v93 offset:35072
    s_add_u32 m0, s73, 123904
    s_add_u32 s74, s73, 36864
    buffer_load_dwordx4 v1, s[60:63], s74 offen offset:0 lds
    s_waitcnt lgkmcnt(15)
    v_mfma_f32_16x16x32_bf16 v[80:83], a[88:91], v[32:35], v[80:83]
    ds_read_b64_tr_b16 a[128:129], v94 offset:45056
    ds_read_b64_tr_b16 a[130:131], v94 offset:45312
    v_mfma_f32_16x16x32_bf16 v[84:87], a[92:95], v[16:19], 0
    s_waitcnt lgkmcnt(15)
    v_mfma_f32_16x16x32_bf16 v[84:87], a[96:99], v[20:23], v[84:87]
    buffer_load_dwordx4 v1, s[60:63], s74 offen offset:2048 lds
    s_waitcnt lgkmcnt(14)
    v_mfma_f32_16x16x32_bf16 v[84:87], a[100:103], v[24:27], v[84:87]
    v_cvt_pk_bf16_f32 v68, v80, v81
    v_cvt_pk_bf16_f32 v69, v82, v83
    s_waitcnt lgkmcnt(12)
    v_mfma_f32_16x16x32_bf16 v[84:87], a[104:107], v[28:31], v[84:87]
    s_add_u32 m0, s73, 128000
    s_add_u32 s74, s73, 40960
    buffer_load_dwordx4 v1, s[60:63], s74 offen offset:0 lds
    s_waitcnt lgkmcnt(10)
    v_mfma_f32_16x16x32_bf16 v[84:87], a[108:111], v[32:35], v[84:87]
    s_waitcnt lgkmcnt(8)
    v_mfma_f32_16x16x32_bf16 v[80:83], a[112:115], v[16:19], 0
    s_waitcnt lgkmcnt(6)
    v_mfma_f32_16x16x32_bf16 v[80:83], a[116:119], v[20:23], v[80:83]
    s_waitcnt lgkmcnt(4)
    v_mfma_f32_16x16x32_bf16 v[80:83], a[120:123], v[24:27], v[80:83]
    s_nop 1
    v_cvt_pk_bf16_f32 v70, v84, v85
    v_cvt_pk_bf16_f32 v71, v86, v87
    s_waitcnt lgkmcnt(2)
    v_mfma_f32_16x16x32_bf16 v[80:83], a[124:127], v[28:31], v[80:83]
    s_waitcnt lgkmcnt(0)
    v_mfma_f32_16x16x32_bf16 v[80:83], a[128:131], v[32:35], v[80:83]
    s_waitcnt vmcnt(21)
    v_readfirstlane_b32 s64, v88
    s_nop 1
    s_cmp_lg_u32 s64, 0
    s_cbranch_scc1 K_GOTNN
    v_mov_b32 v15, 0
    s_mov_b32 s65, 0
POLL2:
    buffer_load_dword v88, v15, s[52:55], 0 offen sc1
POLLC2:
    s_waitcnt vmcnt(0)
    v_cmp_eq_u32 vcc, 0, v88
    s_add_u32 s65, s65, 1
    s_nop 3
    s_cbranch_vccz POLLD2
    s_sleep 1
    s_cmp_lt_u32 s65, 65536
    s_cbranch_scc1 POLL2
POLLD2:
    v_readfirstlane_b32 s64, v88
K_GOTNN:
    s_waitcnt vmcnt(0)
    s_nop 0
K_PUBD:
    s_nop 6
    v_cvt_pk_bf16_f32 v72, v80, v81
    v_cvt_pk_bf16_f32 v73, v82, v83
    v_mov_b32 v74, 0
    v_mov_b32 v75, 0
    v_accvgpr_write_b32 a90, 0
    v_accvgpr_write_b32 a91, 0
    v_accvgpr_write_b32 a110, 0
    v_accvgpr_write_b32 a111, 0
    v_accvgpr_write_b32 a130, 0
    v_accvgpr_write_b32 a131, 0
    s_mov_b32 s22, 0x3df6384f
    v_mov_b32 v49, 0
    s_barrier
    ds_read_b128 a[72:75], v44 offset:0
    ds_read_b128 a[76:79], v44 offset:64
    ds_read_b128 a[80:83], v44 offset:128
    ds_read_b128 a[84:87], v44 offset:192
    ds_read_b64 a[88:89], v45 offset:0
    ds_read_b128 a[92:95], v44 offset:4608
    ds_read_b128 a[96:99], v44 offset:4672
    ds_read_b128 a[100:103], v44 offset:4736
    ds_read_b128 a[104:107], v44 offset:4800
    ds_read_b64 a[108:109], v45 offset:4608
    s_mov_b64 exec, s[28:29]
    buffer_load_dword v48, v47, s[8:11], 0 offen sc1
    s_mov_b64 exec, -1
    s_waitcnt lgkmcnt(9)
    v_mfma_f32_16x16x32_bf16 v[80:83], a[72:75], v[56:59], 0
    ds_read_b128 a[112:115], v44 offset:9216
    s_waitcnt lgkmcnt(9)
    v_mfma_f32_16x16x32_bf16 v[80:83], a[76:79], v[60:63], v[80:83]
    ds_read_b128 a[116:119], v44 offset:9280
    s_waitcnt lgkmcnt(9)
    v_mfma_f32_16x16x32_bf16 v[80:83], a[80:83], v[64:67], v[80:83]
    ds_read_b128 a[120:123], v44 offset:9344
    s_waitcnt lgkmcnt(9)
    v_mfma_f32_16x16x32_bf16 v[80:83], a[84:87], v[68:71], v[80:83]
    ds_read_b128 a[124:127], v44 offset:9408
    s_waitcnt lgkmcnt(9)
    v_mfma_f32_16x16x32_bf16 v[80:83], a[88:91], v[72:75], v[80:83]
    ds_read_b64 a[128:129], v45 offset:9216
    s_waitcnt lgkmcnt(9)
    v_mfma_f32_16x16x32_bf16 v[84:87], a[92:95], v[56:59], 0
    ds_read_b128 a[72:75], v44 offset:13824
    s_waitcnt lgkmcnt(9)
    v_mfma_f32_16x16x32_bf16 v[84:87], a[96:99], v[60:63], v[84:87]
    ds_read_b128 a[76:79], v44 offset:13888
    s_waitcnt lgkmcnt(9)
    v_mfma_f32_16x16x32_bf16 v[84:87], a[100:103], v[64:67], v[84:87]
    ds_read_b128 a[80:83], v44 offset:13952
    v_mul_f32 v80, s22, v80
    v_mul_f32 v81, s22, v81
    v_mul_f32 v82, s22, v82
    s_waitcnt lgkmcnt(9)
    v_mfma_f32_16x16x32_bf16 v[84:87], a[104:107], v[68:71], v[84:87]
    ds_read_b128 a[84:87], v44 offset:14016
    v_mul_f32 v83, s22, v83
    v_cvt_pk_bf16_f32 v88, v80, v81
    v_cvt_pk_bf16_f32 v89, v82, v83
    s_waitcnt lgkmcnt(9)
    v_mfma_f32_16x16x32_bf16 v[84:87], a[108:111], v[72:75], v[84:87]
    ds_read_b64 a[88:89], v45 offset:13824
    ds_write_b64 v46, v[88:89] offset:0
    v_dot2c_f32_bf16 v49, v88, v88
    v_dot2c_f32_bf16 v49, v89, v89
    s_waitcnt lgkmcnt(10)
    v_mfma_f32_16x16x32_bf16 v[80:83], a[112:115], v[56:59], 0
    ds_read_b128 a[92:95], v44 offset:18432
    s_waitcnt lgkmcnt(10)
    v_mfma_f32_16x16x32_bf16 v[80:83], a[116:119], v[60:63], v[80:83]
    ds_read_b128 a[96:99], v44 offset:18496
    s_waitcnt lgkmcnt(10)
    v_mfma_f32_16x16x32_bf16 v[80:83], a[120:123], v[64:67], v[80:83]
    ds_read_b128 a[100:103], v44 offset:18560
    v_mul_f32 v84, s22, v84
    v_mul_f32 v85, s22, v85
    v_mul_f32 v86, s22, v86
    s_waitcnt lgkmcnt(10)
    v_mfma_f32_16x16x32_bf16 v[80:83], a[124:127], v[68:71], v[80:83]
    ds_read_b128 a[104:107], v44 offset:18624
    v_mul_f32 v87, s22, v87
    v_cvt_pk_bf16_f32 v88, v84, v85
    v_cvt_pk_bf16_f32 v89, v86, v87
    s_waitcnt lgkmcnt(10)
    v_mfma_f32_16x16x32_bf16 v[80:83], a[128:131], v[72:75], v[80:83]
    ds_read_b64 a[108:109], v45 offset:18432
    ds_write_b64 v46, v[88:89] offset:32
    v_dot2c_f32_bf16 v49, v88, v88
    v_dot2c_f32_bf16 v49, v89, v89
    s_waitcnt lgkmcnt(11)
    v_mfma_f32_16x16x32_bf16 v[84:87], a[72:75], v[56:59], 0
    ds_read_b128 a[112:115], v44 offset:23040
    s_waitcnt lgkmcnt(11)
    v_mfma_f32_16x16x32_bf16 v[84:87], a[76:79], v[60:63], v[84:87]
    ds_read_b128 a[116:119], v44 offset:23104
    s_waitcnt lgkmcnt(11)
    v_mfma_f32_16x16x32_bf16 v[84:87], a[80:83], v[64:67], v[84:87]
    ds_read_b128 a[120:123], v44 offset:23168
    v_mul_f32 v80, s22, v80
    v_mul_f32 v81, s22, v81
    v_mul_f32 v82, s22, v82
    s_waitcnt lgkmcnt(11)
    v_mfma_f32_16x16x32_bf16 v[84:87], a[84:87], v[68:71], v[84:87]
    ds_read_b128 a[124:127], v44 offset:23232
    v_mul_f32 v83, s22, v83
    v_cvt_pk_bf16_f32 v88, v80, v81
    v_cvt_pk_bf16_f32 v89, v82, v83
    s_waitcnt lgkmcnt(11)
    v_mfma_f32_16x16x32_bf16 v[84:87], a[88:91], v[72:75], v[84:87]
    ds_read_b64 a[128:129], v45 offset:23040
    ds_write_b64 v46, v[88:89] offset:64
    v_dot2c_f32_bf16 v49, v88, v88
    v_dot2c_f32_bf16 v49, v89, v89
    s_waitcnt vmcnt(0)
    v_cmp_ne_u32 vcc, s64, v48
    s_nop 1
    s_and_b64 vcc, vcc, s[28:29]
    s_nop 1
    s_cbranch_vccz CHK3
    s_mov_b64 exec, s[28:29]
    s_mov_b32 s65, 0
POLL3:
    buffer_load_dword v48, v47, s[8:11], 0 offen sc1
POLLC3:
    s_waitcnt vmcnt(0)
    v_cmp_ne_u32 vcc, s64, v48
    s_add_u32 s65, s65, 1
    s_nop 3
    s_cbranch_vccz POLLD3
    s_sleep 1
    s_cmp_lt_u32 s65, 65536
    s_cbranch_scc1 POLL3
POLLD3:
    s_mov_b64 exec, -1
CHK3:
    v_accvgpr_read_b32 v12, a204
    buffer_load_dword a250, v12, s[4:7], 0 offen sc1
    s_mov_b32 m0, s13
    s_nop 0
    buffer_load_dwordx4 v1, s[4:7], s12 offen offset:0 sc1 lds
    buffer_load_dwordx4 v1, s[4:7], s12 offen offset:1024 sc1 lds
    buffer_load_dwordx4 v1, s[4:7], s12 offen offset:2048 sc1 lds
    buffer_load_dwordx4 v1, s[4:7], s12 offen offset:3072 sc1 lds
    s_add_u32 m0, s13, 4096
    s_nop 0
    buffer_load_dwordx4 v2, s[4:7], s12 offen offset:0 sc1 lds
    buffer_load_dwordx4 v2, s[4:7], s12 offen offset:1024 sc1 lds
    s_waitcnt lgkmcnt(11)
    v_mfma_f32_16x16x32_bf16 v[80:83], a[92:95], v[56:59], 0
    ds_read_b128 a[72:75], v44 offset:27648
    s_waitcnt lgkmcnt(11)
    v_mfma_f32_16x16x32_bf16 v[80:83], a[96:99], v[60:63], v[80:83]
    ds_read_b128 a[76:79], v44 offset:27712
    s_waitcnt lgkmcnt(11)
    v_mfma_f32_16x16x32_bf16 v[80:83], a[100:103], v[64:67], v[80:83]
    ds_read_b128 a[80:83], v44 offset:27776
    v_mul_f32 v84, s22, v84
    v_mul_f32 v85, s22, v85
    v_mul_f32 v86, s22, v86
    s_waitcnt lgkmcnt(11)
    v_mfma_f32_16x16x32_bf16 v[80:83], a[104:107], v[68:71], v[80:83]
    ds_read_b128 a[84:87], v44 offset:27840
    v_mul_f32 v87, s22, v87
    v_cvt_pk_bf16_f32 v88, v84, v85
    v_cvt_pk_bf16_f32 v89, v86, v87
    s_waitcnt lgkmcnt(11)
    v_mfma_f32_16x16x32_bf16 v[80:83], a[108:111], v[72:75], v[80:83]
    ds_read_b64 a[88:89], v45 offset:27648
    ds_write_b64 v46, v[88:89] offset:96
    v_dot2c_f32_bf16 v49, v88, v88
    v_dot2c_f32_bf16 v49, v89, v89
    s_waitcnt lgkmcnt(11)
    v_mfma_f32_16x16x32_bf16 v[84:87], a[112:115], v[56:59], 0
    ds_read_b128 a[92:95], v44 offset:32256
    s_waitcnt lgkmcnt(11)
    v_mfma_f32_16x16x32_bf16 v[84:87], a[116:119], v[60:63], v[84:87]
    ds_read_b128 a[96:99], v44 offset:32320
    buffer_load_dwordx4 v2, s[4:7], s12 offen offset:2048 sc1 lds
    buffer_load_dwordx4 v2, s[4:7], s12 offen offset:3072 sc1 lds
    s_waitcnt lgkmcnt(11)
    v_mfma_f32_16x16x32_bf16 v[84:87], a[120:123], v[64:67], v[84:87]
    ds_read_b128 a[100:103], v44 offset:32384
    v_mul_f32 v80, s22, v80
    v_mul_f32 v81, s22, v81
    v_mul_f32 v82, s22, v82
    s_waitcnt lgkmcnt(11)
    v_mfma_f32_16x16x32_bf16 v[84:87], a[124:127], v[68:71], v[84:87]
    ds_read_b128 a[104:107], v44 offset:32448
    v_mul_f32 v83, s22, v83
    v_cvt_pk_bf16_f32 v88, v80, v81
    v_cvt_pk_bf16_f32 v89, v82, v83
    s_waitcnt lgkmcnt(11)
    v_mfma_f32_16x16x32_bf16 v[84:87], a[128:131], v[72:75], v[84:87]
    ds_read_b64 a[108:109], v45 offset:32256
    ds_write_b64 v46, v[88:89] offset:128
    v_dot2c_f32_bf16 v49, v88, v88
    v_dot2c_f32_bf16 v49, v89, v89
    s_waitcnt lgkmcnt(11)
    v_mfma_f32_16x16x32_bf16 v[80:83], a[72:75], v[56:59], 0
    ds_read_b128 a[112:115], v44 offset:36864
    s_waitcnt lgkmcnt(11)
    v_mfma_f32_16x16x32_bf16 v[80:83], a[76:79], v[60:63], v[80:83]
    ds_read_b128 a[116:119], v44 offset:36928
    s_add_u32 m0, s13, 8192
    s_nop 0
    buffer_load_dwordx4 v3, s[4:7], s12 offen offset:0 sc1 lds
    s_waitcnt lgkmcnt(11)
    v_mfma_f32_16x16x32_bf16 v[80:83], a[80:83], v[64:67], v[80:83]
    ds_read_b128 a[120:123], v44 offset:36992
    v_mul_f32 v84, s22, v84
    v_mul_f32 v85, s22, v85
    v_mul_f32 v86, s22, v86
    s_waitcnt lgkmcnt(11)
    v_mfma_f32_16x16x32_bf16 v[80:83], a[84:87], v[68:71], v[80:83]
    ds_read_b128 a[124:127], v44 offset:37056
    v_mul_f32 v87, s22, v87
    v_cvt_pk_bf16_f32 v88, v84, v85
    v_cvt_pk_bf16_f32 v89, v86, v87
    s_waitcnt lgkmcnt(11)
    v_mfma_f32_16x16x32_bf16 v[80:83], a[88:91], v[72:75], v[80:83]
    ds_read_b64 a[128:129], v45 offset:36864
    ds_write_b64 v46, v[88:89] offset:160
    v_dot2c_f32_bf16 v49, v88, v88
    v_dot2c_f32_bf16 v49, v89, v89
    s_waitcnt lgkmcnt(11)
    v_mfma_f32_16x16x32_bf16 v[84:87], a[92:95], v[56:59], 0
    s_waitcnt lgkmcnt(10)
    v_mfma_f32_16x16x32_bf16 v[84:87], a[96:99], v[60:63], v[84:87]
    buffer_load_dwordx4 v3, s[4:7], s12 offen offset:1024 sc1 lds
    s_waitcnt lgkmcnt(9)
    v_mfma_f32_16x16x32_bf16 v[84:87], a[100:103], v[64:67], v[84:87]
    v_mul_f32 v80, s22, v80
    v_mul_f32 v81, s22, v81
    v_mul_f32 v82, s22, v82
    s_waitcnt lgkmcnt(8)
    v_mfma_f32_16x16x32_bf16 v[84:87], a[104:107], v[68:71], v[84:87]
    v_mul_f32 v83, s22, v83
    v_cvt_pk_bf16_f32 v88, v80, v81
    v_cvt_pk_bf16_f32 v89, v82, v83
    s_waitcnt lgkmcnt(7)
    v_mfma_f32_16x16x32_bf16 v[84:87], a[108:111], v[72:75], v[84:87]
    ds_write_b64 v46, v[88:89] offset:192
    v_dot2c_f32_bf16 v49, v88, v88
    v_dot2c_f32_bf16 v49, v89, v89
    s_waitcnt lgkmcnt(6)
    v_mfma_f32_16x16x32_bf16 v[80:83], a[112:115], v[56:59], 0
    s_waitcnt lgkmcnt(5)
    v_mfma_f32_16x16x32_bf16 v[80:83], a[116:119], v[60:63], v[80:83]
    s_waitcnt lgkmcnt(4)
    v_mfma_f32_16x16x32_bf16 v[80:83], a[120:123], v[64:67], v[80:83]
    v_mul_f32 v84, s22, v84
    v_mul_f32 v85, s22, v85
    v_mul_f32 v86, s22, v86
    s_waitcnt lgkmcnt(3)
    v_mfma_f32_16x16x32_bf16 v[80:83], a[124:127], v[68:71], v[80:83]
    v_mul_f32 v87, s22, v87
    v_cvt_pk_bf16_f32 v88, v84, v85
    v_cvt_pk_bf16_f32 v89, v86, v87
    s_waitcnt lgkmcnt(2)
    v_mfma_f32_16x16x32_bf16 v[80:83], a[128:131], v[72:75], v[80:83]
    ds_write_b64 v46, v[88:89] offset:224
    v_dot2c_f32_bf16 v49, v88, v88
    v_dot2c_f32_bf16 v49, v89, v89
    s_nop 4
    v_mul_f32 v80, s22, v80
    v_mul_f32 v81, s22, v81
    v_mul_f32 v82, s22, v82
    v_mul_f32 v83, s22, v83
    v_cvt_pk_bf16_f32 v88, v80, v81
    v_cvt_pk_bf16_f32 v89, v82, v83
    ds_write_b64 v46, v[88:89] offset:256
    v_dot2c_f32_bf16 v49, v88, v88
    v_dot2c_f32_bf16 v49, v89, v89
    s_add_u32 s12, s12, 10240
    s_mov_b32 m0, s14
    v_mov_b32 v50, v49
    s_nop 1
    v_permlane16_swap_b32 v49, v50
    v_add_f32 v49, v49, v50
    v_mov_b32 v50, v49
    buffer_load_dwordx4 v1, s[4:7], s12 offen offset:0 sc1 lds
    s_nop 0
    v_permlane32_swap_b32 v49, v50
    v_add_f32 v49, v49, v50
    v_mov_b32 v51, 0x4289bd1a
    v_cmp_nle_f32 vcc, v49, v51
    s_nop 1
    s_cmp_lg_u64 vcc, 0
    buffer_load_dwordx4 v1, s[4:7], s12 offen offset:1024 sc1 lds
    s_cselect_b32 s3, 1, 0
    v_mov_b32 v50, s3
    s_lshl_b32 s3, s19, 2
    s_add_u32 s3, s3, 128512
    buffer_load_dwordx4 v1, s[4:7], s12 offen offset:2048 sc1 lds
    v_mov_b32 v51, s3
    ds_write_b32 v51, v50
    v_and_b32 v12, 15, v0
    v_bfe_u32 v13, v0, 4, 1
    v_lshrrev_b32 v14, 5, v0
    buffer_load_dwordx4 v1, s[4:7], s12 offen offset:3072 sc1 lds
    s_add_u32 s3, s19, 1
    v_add_u32 v15, s3, v13
    v_and_b32 v15, 3, v15
    v_lshl_add_u32 v15, v15, 4, v12
    s_add_u32 m0, s14, 4096
    v_mul_u32_u24 v15, 304, v15
    v_lshl_add_u32 v15, v14, 4, v15
    v_add_u32 v53, 129024, v15
    s_add_u32 s3, s3, 2
    v_add_u32 v15, s3, v13
    buffer_load_dwordx4 v2, s[4:7], s12 offen offset:0 sc1 lds
    v_and_b32 v15, 3, v15
    v_lshl_add_u32 v15, v15, 4, v12
    v_mul_u32_u24 v15, 304, v15
    v_lshl_add_u32 v15, v14, 4, v15
    v_add_u32 v54, 129024, v15
    s_waitcnt lgkmcnt(0)
    s_barrier
    v_mov_b32 v52, 128512
    ds_read_b128 v[56:59], v52
    ds_read_b128 a[0:3], v53 offset:0
    ds_read_b128 a[36:39], v54 offset:0
    ds_read_b128 a[4:7], v53 offset:32
    ds_read_b128 a[40:43], v54 offset:32
    ds_read_b128 a[8:11], v53 offset:64
    ds_read_b128 a[44:47], v54 offset:64
    buffer_load_dwordx4 v2, s[4:7], s12 offen offset:1024 sc1 lds
    buffer_load_dwordx4 v2, s[4:7], s12 offen offset:2048 sc1 lds
    buffer_load_dwordx4 v2, s[4:7], s12 offen offset:3072 sc1 lds
    s_add_u32 m0, s14, 8192
    s_nop 0
    buffer_load_dwordx4 v3, s[4:7], s12 offen offset:0 sc1 lds
    buffer_load_dwordx4 v3, s[4:7], s12 offen offset:1024 sc1 lds
    s_add_u32 s12, s12, 10240
    s_mov_b64 exec, s[38:39]
    buffer_load_dword v48, v47, s[8:11], 0 offen sc1
    s_mov_b64 exec, -1
    s_waitcnt lgkmcnt(6)
    v_or3_b32 v56, v56, v57, v58
    v_or_b32 v56, v56, v59
    s_nop 0
    v_readfirstlane_b32 s31, v56
    s_lshl_b32 s26, s23, 5
    s_sub_u32 s27, s26, 8
    s_mul_i32 s27, s27, 320
    s_mov_b32 s90, 0xffff
    s_mov_b32 s91, 0xffff
    s_mov_b32 s92, 0xffff0000
    s_mov_b32 s93, 0xffff0000
    s_lshl_b32 s3, s17, 2
    s_add_u32 s3, s3, s19
    s_cmp_eq_u32 s3, 7
    s_cselect_b32 s94, 0, 1.0
    s_mov_b32 s95, s94
    s_add_u32 s3, s19, 0
    s_min_u32 s3, s3, 14
    s_lshl_b32 s3, s3, 10
    s_add_u32 s77, s3, 148480
    s_add_u32 s81, s3, s27
    s_add_u32 s3, s19, 4
    s_min_u32 s3, s3, 14
    s_lshl_b32 s3, s3, 10
    s_add_u32 s78, s3, 148480
    s_add_u32 s82, s3, s27
    s_add_u32 s3, s19, 8
    s_min_u32 s3, s3, 14
    s_lshl_b32 s3, s3, 10
    s_add_u32 s79, s3, 148480
    s_add_u32 s83, s3, s27
    s_add_u32 s3, s19, 12
    s_min_u32 s3, s3, 14
    s_lshl_b32 s3, s3, 10
    s_add_u32 s80, s3, 148480
    s_add_u32 s84, s3, s27
    s_lshl_b32 s3, s17, 1
    s_xor_b32 s3, s3, s19
    s_xor_b32 s73, s3, 2
    s_lshl_b32 s3, s73, 1
    s_add_u32 s3, s3, 1
    s_cmp_eq_u32 s73, 0
    s_cselect_b32 s85, 0, s3
    s_mul_i32 s3, s73, 3
    s_sub_u32 s3, s3, 2
    s_cmp_eq_u32 s73, 0
    s_cselect_b32 s86, 0, s3
    s_mul_i32 s3, s86, 5120
    s_add_u32 s76, s3, 2686976
    s_mul_i32 s3, s85, 5120
    s_add_u32 s74, s3, 2733056
    s_cmp_eq_u32 s73, 0
    s_cselect_b32 s75, 2743296, s76
    s_add_u32 s35, s74, 5120
    s_add_u32 s3, s76, 5120
    s_cmp_eq_u32 s73, 0
    s_cselect_b32 s87, s76, s3
    s_add_u32 s88, s76, 10240
    s_cmp_eq_u32 s73, 0
    s_cselect_b32 s88, s87, s88
    s_cmp_eq_u32 s73, 3
    s_cselect_b32 s88, s87, s88
    s_mul_i32 s89, s19, 10240
    s_add_u32 s89, s89, 46080
    s_mul_i32 s36, s19, 18432
    s_add_u32 s36, s36, 2818048
    s_add_u32 s37, s36, 9216
    v_lshlrev_b32 v13, 6, v0
    v_add_u32 v13, 8585216, v13
    v_subrev_u32 v14, 16, v0
    v_lshrrev_b32 v15, 1, v14
    s_sub_u32 s3, s23, 1
    v_add_u32 v15, s3, v15
    s_mov_b32 s3, 125
    v_cmp_gt_u32 s[28:29], s3, v15
    s_lshl_b32 s3, s16, 7
    v_add_u32 v15, s3, v15
    v_lshlrev_b32 v15, 6, v15
    v_and_b32 v14, 1, v14
    v_lshl_add_u32 v15, v14, 2, v15
    v_add_u32 v15, 8388608, v15
    v_cmp_gt_u32 vcc, 16, v0
    s_nop 1
    v_cndmask_b32 v13, v15, v13, vcc
    s_and_b64 s[28:29], s[28:29], 0x3fffff
    s_or_b64 s[28:29], s[28:29], 0xffff
    s_cmp_lg_u32 s31, 0
    s_cbranch_scc1 K_SLOW
    v_add_u32 v8, s13, v4
    v_add_u32 v9, s13, v5
    s_waitcnt vmcnt(11)
    ds_read_b128 a[148:151], v8 offset:0
    ds_read_b128 a[152:155], v9 offset:0
    ds_read_b128 a[156:159], v8 offset:64
    v_add_u32 v10, s13, v6
    v_add_u32 v11, s13, v7
    s_waitcnt vmcnt(0)
    v_cmp_ne_u32 vcc, s64, v48
    s_nop 1
    s_and_b64 vcc, vcc, s[38:39]
    s_nop 1
    s_cbranch_vccz CHK4
    s_mov_b64 exec, s[38:39]
    s_mov_b32 s65, 0
POLL4:
    buffer_load_dword v48, v47, s[8:11], 0 offen sc1
POLLC4:
    s_waitcnt vmcnt(0)
    v_cmp_ne_u32 vcc, s64, v48
    s_add_u32 s65, s65, 1
    s_nop 3
    s_cbranch_vccz POLLD4
    s_sleep 1
    s_cmp_lt_u32 s65, 65536
    s_cbranch_scc1 POLL4
POLLD4:
    s_mov_b64 exec, -1
CHK4:
    s_waitcnt lgkmcnt(2)
    v_mfma_f32_32x32x16_bf16 v[16:31], a[148:151], a[0:3], 0
    ds_read_b128 a[12:15], v53 offset:96
    ds_read_b128 a[160:163], v9 offset:64
    v_mfma_f32_32x32x16_bf16 v[32:47], a[148:151], a[36:39], 0
    ds_read_b128 a[48:51], v54 offset:96
    ds_read_b64_tr_b16 a[108:109], v10 offset:0
    s_waitcnt lgkmcnt(5)
    v_mfma_f32_32x32x16_bf16 v[16:31], a[152:155], a[4:7], v[16:31]
    ds_read_b128 a[16:19], v53 offset:128
    ds_read_b128 a[164:167], v8 offset:128
    s_mov_b32 m0, s15
    v_mfma_f32_32x32x16_bf16 v[32:47], a[152:155], a[40:43], v[32:47]
    ds_read_b128 a[52:55], v54 offset:128
    ds_read_b64_tr_b16 a[110:111], v10 offset:5120
    buffer_load_dwordx4 v1, s[4:7], s12 offen offset:0 sc1 lds
    s_waitcnt lgkmcnt(8)
    v_mfma_f32_32x32x16_bf16 v[16:31], a[156:159], a[8:11], v[16:31]
    ds_read_b128 a[20:23], v53 offset:160
    ds_read_b128 a[168:171], v9 offset:128
    buffer_load_dwordx4 v1, s[4:7], s12 offen offset:1024 sc1 lds
    v_mfma_f32_32x32x16_bf16 v[32:47], a[156:159], a[44:47], v[32:47]
    ds_read_b128 a[56:59], v54 offset:160
    ds_read_b64_tr_b16 a[112:113], v11 offset:0
    buffer_load_dwordx4 v1, s[4:7], s12 offen offset:2048 sc1 lds
    s_waitcnt lgkmcnt(10)
    v_mfma_f32_32x32x16_bf16 v[16:31], a[160:163], a[12:15], v[16:31]
    ds_read_b128 a[24:27], v53 offset:192
    ds_read_b128 a[172:175], v8 offset:192
    s_waitcnt lgkmcnt(11)
    v_mfma_f32_32x32x16_bf16 v[32:47], a[160:163], a[48:51], v[32:47]
    ds_read_b128 a[60:63], v54 offset:192
    ds_read_b64_tr_b16 a[114:115], v11 offset:5120
    buffer_load_dwordx4 v1, s[4:7], s12 offen offset:3072 sc1 lds
    s_waitcnt lgkmcnt(10)
    v_mfma_f32_32x32x16_bf16 v[16:31], a[164:167], a[16:19], v[16:31]
    ds_read_b128 a[28:31], v53 offset:224
    ds_read_b128 a[176:179], v9 offset:192
    s_add_u32 m0, s15, 4096
    s_waitcnt lgkmcnt(11)
    v_mfma_f32_32x32x16_bf16 v[32:47], a[164:167], a[52:55], v[32:47]
    ds_read_b128 a[64:67], v54 offset:224
    ds_read_b64_tr_b16 a[116:117], v10 offset:64
    buffer_load_dwordx4 v2, s[4:7], s12 offen offset:0 sc1 lds
    s_waitcnt lgkmcnt(10)
    v_mfma_f32_32x32x16_bf16 v[16:31], a[168:171], a[20:23], v[16:31]
    ds_read_b128 a[32:35], v53 offset:256
    ds_read_b128 a[180:183], v8 offset:256
    buffer_load_dwordx4 v2, s[4:7], s12 offen offset:1024 sc1 lds
    s_waitcnt lgkmcnt(11)
    v_mfma_f32_32x32x16_bf16 v[32:47], a[168:171], a[56:59], v[32:47]
    ds_read_b128 a[68:71], v54 offset:256
    ds_read_b64_tr_b16 a[118:119], v10 offset:5184
    buffer_load_dwordx4 v2, s[4:7], s12 offen offset:2048 sc1 lds
    s_waitcnt lgkmcnt(10)
    v_mfma_f32_32x32x16_bf16 v[16:31], a[172:175], a[24:27], v[16:31]
    ds_read_b64_tr_b16 a[120:121], v11 offset:64
    ds_read_b64_tr_b16 a[122:123], v11 offset:5184
    s_waitcnt lgkmcnt(11)
    v_mfma_f32_32x32x16_bf16 v[32:47], a[172:175], a[60:63], v[32:47]
    ds_read_b64_tr_b16 a[124:125], v10 offset:128
    ds_read_b64_tr_b16 a[126:127], v10 offset:5248
    buffer_load_dwordx4 v2, s[4:7], s12 offen offset:3072 sc1 lds
    s_waitcnt lgkmcnt(10)
    v_mfma_f32_32x32x16_bf16 v[16:31], a[176:179], a[28:31], v[16:31]
    ds_read_b64_tr_b16 a[128:129], v11 offset:128
    ds_read_b64_tr_b16 a[130:131], v11 offset:5248
    s_add_u32 m0, s15, 8192
    s_waitcnt lgkmcnt(11)
    v_mfma_f32_32x32x16_bf16 v[32:47], a[176:179], a[64:67], v[32:47]
    ds_read_b64_tr_b16 a[132:133], v10 offset:192
    ds_read_b64_tr_b16 a[134:135], v10 offset:5312
    buffer_load_dwordx4 v3, s[4:7], s12 offen offset:0 sc1 lds
    s_waitcnt lgkmcnt(10)
    v_mfma_f32_32x32x16_bf16 v[16:31], a[180:183], a[32:35], v[16:31]
    ds_read_b64_tr_b16 a[136:137], v11 offset:192
    ds_read_b64_tr_b16 a[138:139], v11 offset:5312
    buffer_load_dwordx4 v3, s[4:7], s12 offen offset:1024 sc1 lds
    s_waitcnt lgkmcnt(11)
    v_mfma_f32_32x32x16_bf16 v[32:47], a[180:183], a[68:71], v[32:47]
    ds_read_b64_tr_b16 a[140:141], v10 offset:256
    ds_read_b64_tr_b16 a[142:143], v10 offset:5376
    s_add_u32 s12, s12, 10240
    v_add_u32 v8, s14, v4
    v_add_u32 v9, s14, v5
    ds_read_b128 a[72:75], v8 offset:0
    ds_read_b128 a[76:79], v9 offset:0
    ds_read_b128 a[80:83], v8 offset:64
    ds_read_b128 a[84:87], v9 offset:64
    ds_read_b128 a[88:91], v8 offset:128
    ds_read_b128 a[92:95], v9 offset:128
    ds_read_b128 a[96:99], v8 offset:192
    ds_read_b128 a[100:103], v9 offset:192
    ds_read_b128 a[104:107], v8 offset:256
    s_mov_b32 s20, 0
K_LOOP:
    s_waitcnt lgkmcnt(0)
    v_mfma_f32_32x32x16_bf16 v[48:63], a[72:75], a[0:3], 0
    s_mov_b32 m0, s13
    v_exp_f32 v16, v16
    v_exp_f32 v17, v17
    v_mfma_f32_32x32x16_bf16 v[64:79], a[72:75], a[36:39], 0
    buffer_load_dwordx4 v1, s[4:7], s12 offen offset:0 sc1 lds
    v_exp_f32 v20, v20
    v_exp_f32 v21, v21
    v_mfma_f32_32x32x16_bf16 v[48:63], a[76:79], a[4:7], v[48:63]
    v_cvt_pk_bf16_f32 v80, v16, v17
    v_cvt_pk_bf16_f32 v84, v20, v21
    v_exp_f32 v18, v18
    v_mfma_f32_32x32x16_bf16 v[64:79], a[76:79], a[40:43], v[64:79]
    buffer_load_dwordx4 v1, s[4:7], s12 offen offset:1024 sc1 lds
    v_exp_f32 v19, v19
    v_exp_f32 v22, v22
    v_mfma_f32_32x32x16_bf16 v[48:63], a[80:83], a[8:11], v[48:63]
    buffer_load_dwordx4 v1, s[4:7], s12 offen offset:2048 sc1 lds
    v_exp_f32 v23, v23
    v_cvt_pk_bf16_f32 v81, v18, v19
    v_cvt_pk_bf16_f32 v85, v22, v23
    v_mfma_f32_32x32x16_bf16 v[64:79], a[80:83], a[44:47], v[64:79]
    v_permlane16_swap_b32 v80, v84
    v_exp_f32 v24, v24
    v_exp_f32 v25, v25
    v_mfma_f32_32x32x16_bf16 v[48:63], a[84:87], a[12:15], v[48:63]
    buffer_load_dwordx4 v1, s[4:7], s12 offen offset:3072 sc1 lds
    s_add_u32 m0, s13, 4096
    v_exp_f32 v28, v28
    v_mfma_f32_32x32x16_bf16 v[64:79], a[84:87], a[48:51], v[64:79]
    v_exp_f32 v29, v29
    v_cvt_pk_bf16_f32 v82, v24, v25
    v_cvt_pk_bf16_f32 v86, v28, v29
    v_permlane16_swap_b32 v81, v85
    v_mfma_f32_32x32x16_bf16 v[48:63], a[88:91], a[16:19], v[48:63]
    buffer_load_dwordx4 v2, s[4:7], s12 offen offset:0 sc1 lds
    v_exp_f32 v26, v26
    v_exp_f32 v27, v27
    v_mfma_f32_32x32x16_bf16 v[64:79], a[88:91], a[52:55], v[64:79]
    buffer_load_dwordx4 v2, s[4:7], s12 offen offset:1024 sc1 lds
    v_exp_f32 v30, v30
    v_exp_f32 v31, v31
    v_mfma_f32_32x32x16_bf16 v[48:63], a[92:95], a[20:23], v[48:63]
    v_cvt_pk_bf16_f32 v83, v26, v27
    v_cvt_pk_bf16_f32 v87, v30, v31
    v_permlane16_swap_b32 v82, v86
    s_nop 0
    v_permlane16_swap_b32 v83, v87
    v_exp_f32 v32, v32
    v_mfma_f32_32x32x16_bf16 v[64:79], a[92:95], a[56:59], v[64:79]
    buffer_load_dwordx4 v2, s[4:7], s12 offen offset:2048 sc1 lds
    v_exp_f32 v33, v33
    v_exp_f32 v36, v36
    v_mfma_f32_32x32x16_bf16 v[48:63], a[96:99], a[24:27], v[48:63]
    buffer_load_dwordx4 v2, s[4:7], s12 offen offset:3072 sc1 lds
    s_add_u32 m0, s13, 8192
    v_exp_f32 v37, v37
    v_mfma_f32_32x32x16_bf16 v[64:79], a[96:99], a[60:63], v[64:79]
    v_cvt_pk_bf16_f32 v88, v32, v33
    v_cvt_pk_bf16_f32 v92, v36, v37
    v_exp_f32 v34, v34
    v_mfma_f32_32x32x16_bf16 v[48:63], a[100:103], a[28:31], v[48:63]
    buffer_load_dwordx4 v3, s[4:7], s12 offen offset:0 sc1 lds
    v_exp_f32 v35, v35
    v_exp_f32 v38, v38
    v_mfma_f32_32x32x16_bf16 v[64:79], a[100:103], a[64:67], v[64:79]
    buffer_load_dwordx4 v3, s[4:7], s12 offen offset:1024 sc1 lds
    v_exp_f32 v39, v39
    v_cvt_pk_bf16_f32 v89, v34, v35
    v_cvt_pk_bf16_f32 v93, v38, v39
    v_mfma_f32_32x32x16_bf16 v[48:63], a[104:107], a[32:35], v[48:63]
    s_add_u32 s12, s12, 10240
    v_permlane16_swap_b32 v88, v92
    v_exp_f32 v40, v40
    v_exp_f32 v41, v41
    v_mfma_f32_32x32x16_bf16 v[64:79], a[104:107], a[68:71], v[64:79]
    v_add_u32 v10, s14, v6
    v_add_u32 v11, s14, v7
    v_add_u32 v8, s15, v4
    v_add_u32 v9, s15, v5
    v_mfma_f32_16x16x32_bf16 v[96:99], a[108:111], v[80:83], v[96:99]
    v_exp_f32 v44, v44
    v_mfma_f32_16x16x32_bf16 v[136:139], a[108:111], v[84:87], v[136:139]
    v_exp_f32 v45, v45
    v_mfma_f32_16x16x32_bf16 v[100:103], a[112:115], v[80:83], v[100:103]
    ds_read_b64_tr_b16 a[148:149], v10 offset:0
    v_cvt_pk_bf16_f32 v90, v40, v41
    v_mfma_f32_16x16x32_bf16 v[140:143], a[112:115], v[84:87], v[140:143]
    ds_read_b64_tr_b16 a[150:151], v10 offset:5120
    v_cvt_pk_bf16_f32 v94, v44, v45
    v_mfma_f32_16x16x32_bf16 v[104:107], a[116:119], v[80:83], v[104:107]
    ds_read_b64_tr_b16 a[152:153], v11 offset:0
    v_permlane16_swap_b32 v89, v93
    v_mfma_f32_16x16x32_bf16 v[144:147], a[116:119], v[84:87], v[144:147]
    v_exp_f32 v42, v42
    v_mfma_f32_16x16x32_bf16 v[108:111], a[120:123], v[80:83], v[108:111]
    v_exp_f32 v43, v43
    v_mfma_f32_16x16x32_bf16 v[148:151], a[120:123], v[84:87], v[148:151]
    v_exp_f32 v46, v46
    v_mfma_f32_16x16x32_bf16 v[112:115], a[124:127], v[80:83], v[112:115]
    v_exp_f32 v47, v47
    v_mfma_f32_16x16x32_bf16 v[152:155], a[124:127], v[84:87], v[152:155]
    ds_read_b64_tr_b16 a[154:155], v11 offset:5120
    v_cvt_pk_bf16_f32 v91, v42, v43
    v_mfma_f32_16x16x32_bf16 v[116:119], a[128:131], v[80:83], v[116:119]
    ds_read_b64_tr_b16 a[156:157], v10 offset:64
    v_cvt_pk_bf16_f32 v95, v46, v47
    v_mfma_f32_16x16x32_bf16 v[156:159], a[128:131], v[84:87], v[156:159]
    ds_read_b64_tr_b16 a[158:159], v10 offset:5184
    v_permlane16_swap_b32 v90, v94
    v_mfma_f32_16x16x32_bf16 v[120:123], a[132:135], v[80:83], v[120:123]
    ds_read_b64_tr_b16 a[160:161], v11 offset:64
    v_permlane16_swap_b32 v91, v95
    v_mfma_f32_16x16x32_bf16 v[160:163], a[132:135], v[84:87], v[160:163]
    ds_read_b64_tr_b16 a[162:163], v11 offset:5184
    v_add_f32 v134, v134, v16
    v_mfma_f32_16x16x32_bf16 v[124:127], a[136:139], v[80:83], v[124:127]
    ds_read_b64_tr_b16 a[164:165], v10 offset:128
    v_add_f32 v135, v135, v17
    v_mfma_f32_16x16x32_bf16 v[164:167], a[136:139], v[84:87], v[164:167]
    ds_read_b64_tr_b16 a[166:167], v10 offset:5248
    v_add_f32 v134, v134, v20
    v_mfma_f32_16x16x32_bf16 v[128:131], a[140:143], v[80:83], v[128:131]
    ds_read_b64_tr_b16 a[168:169], v11 offset:128
    v_add_f32 v135, v135, v21
    v_mfma_f32_16x16x32_bf16 v[168:171], a[140:143], v[84:87], v[168:171]
    ds_read_b64_tr_b16 a[170:171], v11 offset:5248
    v_add_f32 v134, v134, v18
    v_mfma_f32_16x16x32_bf16 v[176:179], a[108:111], v[88:91], v[176:179]
    ds_read_b64_tr_b16 a[172:173], v10 offset:192
    v_add_f32 v135, v135, v19
    v_mfma_f32_16x16x32_bf16 v[216:219], a[108:111], v[92:95], v[216:219]
    ds_read_b64_tr_b16 a[174:175], v10 offset:5312
    v_add_f32 v134, v134, v22
    v_mfma_f32_16x16x32_bf16 v[180:183], a[112:115], v[88:91], v[180:183]
    ds_read_b64_tr_b16 a[176:177], v11 offset:192
    v_add_f32 v135, v135, v23
    v_mfma_f32_16x16x32_bf16 v[220:223], a[112:115], v[92:95], v[220:223]
    ds_read_b64_tr_b16 a[178:179], v11 offset:5312
    v_add_f32 v134, v134, v24
    v_mfma_f32_16x16x32_bf16 v[184:187], a[116:119], v[88:91], v[184:187]
    ds_read_b64_tr_b16 a[180:181], v10 offset:256
    v_add_f32 v135, v135, v25
    v_mfma_f32_16x16x32_bf16 v[224:227], a[116:119], v[92:95], v[224:227]
    ds_read_b64_tr_b16 a[182:183], v10 offset:5376
    v_add_f32 v134, v134, v28
    v_mfma_f32_16x16x32_bf16 v[188:191], a[120:123], v[88:91], v[188:191]
    s_waitcnt vmcnt(10)
    ds_read_b128 a[72:75], v8 offset:0
    v_add_f32 v135, v135, v29
    v_mfma_f32_16x16x32_bf16 v[228:231], a[120:123], v[92:95], v[228:231]
    ds_read_b128 a[76:79], v9 offset:0
    v_add_f32 v134, v134, v26
    v_mfma_f32_16x16x32_bf16 v[192:195], a[124:127], v[88:91], v[192:195]
    ds_read_b128 a[80:83], v8 offset:64
    v_add_f32 v135, v135, v27
    v_mfma_f32_16x16x32_bf16 v[232:235], a[124:127], v[92:95], v[232:235]
    ds_read_b128 a[84:87], v9 offset:64
    v_add_f32 v134, v134, v30
    v_mfma_f32_16x16x32_bf16 v[196:199], a[128:131], v[88:91], v[196:199]
    ds_read_b128 a[88:91], v8 offset:128
    v_add_f32 v135, v135, v31
    v_mfma_f32_16x16x32_bf16 v[236:239], a[128:131], v[92:95], v[236:239]
    ds_read_b128 a[92:95], v9 offset:128
    v_add_f32 v214, v214, v32
    v_mfma_f32_16x16x32_bf16 v[200:203], a[132:135], v[88:91], v[200:203]
    ds_read_b128 a[96:99], v8 offset:192
    v_add_f32 v215, v215, v33
    v_mfma_f32_16x16x32_bf16 v[240:243], a[132:135], v[92:95], v[240:243]
    ds_read_b128 a[100:103], v9 offset:192
    v_add_f32 v214, v214, v36
    v_mfma_f32_16x16x32_bf16 v[204:207], a[136:139], v[88:91], v[204:207]
    ds_read_b128 a[104:107], v8 offset:256
    s_mov_b32 s21, s13
    v_add_f32 v215, v215, v37
    v_mfma_f32_16x16x32_bf16 v[244:247], a[136:139], v[92:95], v[244:247]
    s_mov_b32 s13, s14
    v_add_f32 v214, v214, v34
    v_add_f32 v215, v215, v35
    v_mfma_f32_16x16x32_bf16 v[208:211], a[140:143], v[88:91], v[208:211]
    s_mov_b32 s14, s15
    v_add_f32 v214, v214, v38
    v_add_f32 v215, v215, v39
    v_mfma_f32_16x16x32_bf16 v[248:251], a[140:143], v[92:95], v[248:251]
    s_mov_b32 s15, s21
    v_add_f32 v214, v214, v40
    v_add_f32 v215, v215, v41
    v_add_f32 v214, v214, v44
    v_add_f32 v215, v215, v45
    v_add_f32 v214, v214, v42
    v_add_f32 v215, v215, v43
    v_add_f32 v214, v214, v46
    v_add_f32 v215, v215, v47
    s_waitcnt lgkmcnt(0)
    v_mfma_f32_32x32x16_bf16 v[16:31], a[72:75], a[0:3], 0
    s_mov_b32 m0, s13
    v_exp_f32 v48, v48
    v_exp_f32 v49, v49
    v_mfma_f32_32x32x16_bf16 v[32:47], a[72:75], a[36:39], 0
    buffer_load_dwordx4 v1, s[4:7], s12 offen offset:0 sc1 lds
    v_exp_f32 v52, v52
    v_exp_f32 v53, v53
    v_mfma_f32_32x32x16_bf16 v[16:31], a[76:79], a[4:7], v[16:31]
    v_cvt_pk_bf16_f32 v80, v48, v49
    v_cvt_pk_bf16_f32 v84, v52, v53
    v_exp_f32 v50, v50
    v_mfma_f32_32x32x16_bf16 v[32:47], a[76:79], a[40:43], v[32:47]
    buffer_load_dwordx4 v1, s[4:7], s12 offen offset:1024 sc1 lds
    v_exp_f32 v51, v51
    v_exp_f32 v54, v54
    v_mfma_f32_32x32x16_bf16 v[16:31], a[80:83], a[8:11], v[16:31]
    buffer_load_dwordx4 v1, s[4:7], s12 offen offset:2048 sc1 lds
    v_exp_f32 v55, v55
    v_cvt_pk_bf16_f32 v81, v50, v51
    v_cvt_pk_bf16_f32 v85, v54, v55
    v_mfma_f32_32x32x16_bf16 v[32:47], a[80:83], a[44:47], v[32:47]
    v_permlane16_swap_b32 v80, v84
    v_exp_f32 v56, v56
    v_exp_f32 v57, v57
    v_mfma_f32_32x32x16_bf16 v[16:31], a[84:87], a[12:15], v[16:31]
    buffer_load_dwordx4 v1, s[4:7], s12 offen offset:3072 sc1 lds
    s_add_u32 m0, s13, 4096
    v_exp_f32 v60, v60
    v_mfma_f32_32x32x16_bf16 v[32:47], a[84:87], a[48:51], v[32:47]
    v_exp_f32 v61, v61
    v_cvt_pk_bf16_f32 v82, v56, v57
    v_cvt_pk_bf16_f32 v86, v60, v61
    v_permlane16_swap_b32 v81, v85
    v_mfma_f32_32x32x16_bf16 v[16:31], a[88:91], a[16:19], v[16:31]
    buffer_load_dwordx4 v2, s[4:7], s12 offen offset:0 sc1 lds
    v_exp_f32 v58, v58
    v_exp_f32 v59, v59
    v_mfma_f32_32x32x16_bf16 v[32:47], a[88:91], a[52:55], v[32:47]
    buffer_load_dwordx4 v2, s[4:7], s12 offen offset:1024 sc1 lds
    v_exp_f32 v62, v62
    v_exp_f32 v63, v63
    v_mfma_f32_32x32x16_bf16 v[16:31], a[92:95], a[20:23], v[16:31]
    v_cvt_pk_bf16_f32 v83, v58, v59
    v_cvt_pk_bf16_f32 v87, v62, v63
    v_permlane16_swap_b32 v82, v86
    s_nop 0
    v_permlane16_swap_b32 v83, v87
    v_exp_f32 v64, v64
    v_mfma_f32_32x32x16_bf16 v[32:47], a[92:95], a[56:59], v[32:47]
    buffer_load_dwordx4 v2, s[4:7], s12 offen offset:2048 sc1 lds
    v_exp_f32 v65, v65
    v_exp_f32 v68, v68
    v_mfma_f32_32x32x16_bf16 v[16:31], a[96:99], a[24:27], v[16:31]
    buffer_load_dwordx4 v2, s[4:7], s12 offen offset:3072 sc1 lds
    s_add_u32 m0, s13, 8192
    v_exp_f32 v69, v69
    v_mfma_f32_32x32x16_bf16 v[32:47], a[96:99], a[60:63], v[32:47]
    v_cvt_pk_bf16_f32 v88, v64, v65
    v_cvt_pk_bf16_f32 v92, v68, v69
    v_exp_f32 v66, v66
    v_mfma_f32_32x32x16_bf16 v[16:31], a[100:103], a[28:31], v[16:31]
    buffer_load_dwordx4 v3, s[4:7], s12 offen offset:0 sc1 lds
    v_exp_f32 v67, v67
    v_exp_f32 v70, v70
    v_mfma_f32_32x32x16_bf16 v[32:47], a[100:103], a[64:67], v[32:47]
    buffer_load_dwordx4 v3, s[4:7], s12 offen offset:1024 sc1 lds
    v_exp_f32 v71, v71
    v_cvt_pk_bf16_f32 v89, v66, v67
    v_cvt_pk_bf16_f32 v93, v70, v71
    v_mfma_f32_32x32x16_bf16 v[16:31], a[104:107], a[32:35], v[16:31]
    s_add_u32 s12, s12, 10240
    v_permlane16_swap_b32 v88, v92
    v_exp_f32 v72, v72
    v_exp_f32 v73, v73
    v_mfma_f32_32x32x16_bf16 v[32:47], a[104:107], a[68:71], v[32:47]
    v_add_u32 v10, s14, v6
    v_add_u32 v11, s14, v7
    v_add_u32 v8, s15, v4
    v_add_u32 v9, s15, v5
    v_mfma_f32_16x16x32_bf16 v[96:99], a[148:151], v[80:83], v[96:99]
    v_exp_f32 v76, v76
    v_mfma_f32_16x16x32_bf16 v[136:139], a[148:151], v[84:87], v[136:139]
    v_exp_f32 v77, v77
    v_mfma_f32_16x16x32_bf16 v[100:103], a[152:155], v[80:83], v[100:103]
    ds_read_b64_tr_b16 a[108:109], v10 offset:0
    v_cvt_pk_bf16_f32 v90, v72, v73
    v_mfma_f32_16x16x32_bf16 v[140:143], a[152:155], v[84:87], v[140:143]
    ds_read_b64_tr_b16 a[110:111], v10 offset:5120
    v_cvt_pk_bf16_f32 v94, v76, v77
    v_mfma_f32_16x16x32_bf16 v[104:107], a[156:159], v[80:83], v[104:107]
    ds_read_b64_tr_b16 a[112:113], v11 offset:0
    v_permlane16_swap_b32 v89, v93
    v_mfma_f32_16x16x32_bf16 v[144:147], a[156:159], v[84:87], v[144:147]
    v_exp_f32 v74, v74
    v_mfma_f32_16x16x32_bf16 v[108:111], a[160:163], v[80:83], v[108:111]
    v_exp_f32 v75, v75
    v_mfma_f32_16x16x32_bf16 v[148:151], a[160:163], v[84:87], v[148:151]
    v_exp_f32 v78, v78
    v_mfma_f32_16x16x32_bf16 v[112:115], a[164:167], v[80:83], v[112:115]
    v_exp_f32 v79, v79
    v_mfma_f32_16x16x32_bf16 v[152:155], a[164:167], v[84:87], v[152:155]
    ds_read_b64_tr_b16 a[114:115], v11 offset:5120
    v_cvt_pk_bf16_f32 v91, v74, v75
    v_mfma_f32_16x16x32_bf16 v[116:119], a[168:171], v[80:83], v[116:119]
    ds_read_b64_tr_b16 a[116:117], v10 offset:64
    v_cvt_pk_bf16_f32 v95, v78, v79
    v_mfma_f32_16x16x32_bf16 v[156:159], a[168:171], v[84:87], v[156:159]
    ds_read_b64_tr_b16 a[118:119], v10 offset:5184
    v_permlane16_swap_b32 v90, v94
    v_mfma_f32_16x16x32_bf16 v[120:123], a[172:175], v[80:83], v[120:123]
    ds_read_b64_tr_b16 a[120:121], v11 offset:64
    v_permlane16_swap_b32 v91, v95
    v_mfma_f32_16x16x32_bf16 v[160:163], a[172:175], v[84:87], v[160:163]
    ds_read_b64_tr_b16 a[122:123], v11 offset:5184
    v_add_f32 v134, v134, v48
    v_mfma_f32_16x16x32_bf16 v[124:127], a[176:179], v[80:83], v[124:127]
    ds_read_b64_tr_b16 a[124:125], v10 offset:128
    v_add_f32 v135, v135, v49
    v_mfma_f32_16x16x32_bf16 v[164:167], a[176:179], v[84:87], v[164:167]
    ds_read_b64_tr_b16 a[126:127], v10 offset:5248
    v_add_f32 v134, v134, v52
    v_mfma_f32_16x16x32_bf16 v[128:131], a[180:183], v[80:83], v[128:131]
    ds_read_b64_tr_b16 a[128:129], v11 offset:128
    v_add_f32 v135, v135, v53
    v_mfma_f32_16x16x32_bf16 v[168:171], a[180:183], v[84:87], v[168:171]
    ds_read_b64_tr_b16 a[130:131], v11 offset:5248
    v_add_f32 v134, v134, v50
    v_mfma_f32_16x16x32_bf16 v[176:179], a[148:151], v[88:91], v[176:179]
    ds_read_b64_tr_b16 a[132:133], v10 offset:192
    v_add_f32 v135, v135, v51
    v_mfma_f32_16x16x32_bf16 v[216:219], a[148:151], v[92:95], v[216:219]
    ds_read_b64_tr_b16 a[134:135], v10 offset:5312
    v_add_f32 v134, v134, v54
    v_mfma_f32_16x16x32_bf16 v[180:183], a[152:155], v[88:91], v[180:183]
    ds_read_b64_tr_b16 a[136:137], v11 offset:192
    v_add_f32 v135, v135, v55
    v_mfma_f32_16x16x32_bf16 v[220:223], a[152:155], v[92:95], v[220:223]
    ds_read_b64_tr_b16 a[138:139], v11 offset:5312
    v_add_f32 v134, v134, v56
    v_mfma_f32_16x16x32_bf16 v[184:187], a[156:159], v[88:91], v[184:187]
    ds_read_b64_tr_b16 a[140:141], v10 offset:256
    v_add_f32 v135, v135, v57
    v_mfma_f32_16x16x32_bf16 v[224:227], a[156:159], v[92:95], v[224:227]
    ds_read_b64_tr_b16 a[142:143], v10 offset:5376
    v_add_f32 v134, v134, v60
    v_mfma_f32_16x16x32_bf16 v[188:191], a[160:163], v[88:91], v[188:191]
    v_add_f32 v135, v135, v61
    v_add_f32 v134, v134, v58
    v_mfma_f32_16x16x32_bf16 v[228:231], a[160:163], v[92:95], v[228:231]
    s_waitcnt vmcnt(10)
    ds_read_b128 a[72:75], v8 offset:0
    v_add_f32 v135, v135, v59
    v_mfma_f32_16x16x32_bf16 v[192:195], a[164:167], v[88:91], v[192:195]
    ds_read_b128 a[76:79], v9 offset:0
    v_add_f32 v134, v134, v62
    v_mfma_f32_16x16x32_bf16 v[232:235], a[164:167], v[92:95], v[232:235]
    ds_read_b128 a[80:83], v8 offset:64
    v_add_f32 v135, v135, v63
    v_mfma_f32_16x16x32_bf16 v[196:199], a[168:171], v[88:91], v[196:199]
    ds_read_b128 a[84:87], v9 offset:64
    v_add_f32 v214, v214, v64
    v_mfma_f32_16x16x32_bf16 v[236:239], a[168:171], v[92:95], v[236:239]
    ds_read_b128 a[88:91], v8 offset:128
    v_add_f32 v215, v215, v65
    v_mfma_f32_16x16x32_bf16 v[200:203], a[172:175], v[88:91], v[200:203]
    ds_read_b128 a[92:95], v9 offset:128
    v_add_f32 v214, v214, v68
    v_mfma_f32_16x16x32_bf16 v[240:243], a[172:175], v[92:95], v[240:243]
    ds_read_b128 a[96:99], v8 offset:192
    v_add_f32 v215, v215, v69
    v_mfma_f32_16x16x32_bf16 v[204:207], a[176:179], v[88:91], v[204:207]
    ds_read_b128 a[100:103], v9 offset:192
    s_mov_b32 s21, s13
    v_add_f32 v214, v214, v66
    v_mfma_f32_16x16x32_bf16 v[244:247], a[176:179], v[92:95], v[244:247]
    ds_read_b128 a[104:107], v8 offset:256
    s_mov_b32 s13, s14
    v_add_f32 v215, v215, v67
    v_mfma_f32_16x16x32_bf16 v[208:211], a[180:183], v[88:91], v[208:211]
    buffer_load_dword v12, v13, s[8:11], 0 offen sc1
    s_mov_b32 s14, s15
    v_add_f32 v214, v214, v70
    v_mfma_f32_16x16x32_bf16 v[248:251], a[180:183], v[92:95], v[248:251]
    s_mov_b32 s15, s21
    v_add_f32 v215, v215, v71
    v_add_f32 v214, v214, v72
    v_add_f32 v215, v215, v73
    v_add_f32 v214, v214, v76
    v_add_f32 v215, v215, v77
    v_add_f32 v214, v214, v74
    v_add_f32 v215, v215, v75
    v_add_f32 v214, v214, v78
    v_add_f32 v215, v215, v79
    s_add_u32 s20, s20, 1
    s_cmp_lt_u32 s20, 6
    s_cbranch_scc1 K_LOOP
    s_waitcnt vmcnt(0)
    v_cmp_ne_u32 vcc, s64, v12
    s_nop 1
    s_and_b64 vcc, vcc, s[28:29]
    s_nop 1
    s_cbranch_vccz CHK5
    s_mov_b64 exec, s[28:29]
    s_mov_b32 s65, 0
POLL5:
    buffer_load_dword v12, v13, s[8:11], 0 offen sc1
POLLC5:
    s_waitcnt vmcnt(0)
    v_cmp_ne_u32 vcc, s64, v12
    s_add_u32 s65, s65, 1
    s_nop 3
    s_cbranch_vccz POLLD5
    s_sleep 1
    s_cmp_lt_u32 s65, 65536
    s_cbranch_scc1 POLL5
POLLD5:
    s_mov_b64 exec, -1
CHK5:
    s_waitcnt lgkmcnt(0)
    v_mfma_f32_32x32x16_bf16 v[48:63], a[72:75], a[0:3], 0
    s_mov_b32 m0, s13
    v_exp_f32 v16, v16
    v_exp_f32 v17, v17
    v_mfma_f32_32x32x16_bf16 v[64:79], a[72:75], a[36:39], 0
    buffer_load_dwordx4 v1, s[4:7], s12 offen offset:0 sc1 lds
    v_exp_f32 v20, v20
    v_exp_f32 v21, v21
    v_mfma_f32_32x32x16_bf16 v[48:63], a[76:79], a[4:7], v[48:63]
    v_cvt_pk_bf16_f32 v80, v16, v17
    v_cvt_pk_bf16_f32 v84, v20, v21
    v_exp_f32 v18, v18
    v_mfma_f32_32x32x16_bf16 v[64:79], a[76:79], a[40:43], v[64:79]
    buffer_load_dwordx4 v1, s[4:7], s12 offen offset:1024 sc1 lds
    v_exp_f32 v19, v19
    v_exp_f32 v22, v22
    v_mfma_f32_32x32x16_bf16 v[48:63], a[80:83], a[8:11], v[48:63]
    buffer_load_dwordx4 v1, s[4:7], s12 offen offset:2048 sc1 lds
    v_exp_f32 v23, v23
    v_cvt_pk_bf16_f32 v81, v18, v19
    v_cvt_pk_bf16_f32 v85, v22, v23
    v_mfma_f32_32x32x16_bf16 v[64:79], a[80:83], a[44:47], v[64:79]
    v_permlane16_swap_b32 v80, v84
    v_exp_f32 v24, v24
    v_exp_f32 v25, v25
    v_mfma_f32_32x32x16_bf16 v[48:63], a[84:87], a[12:15], v[48:63]
    buffer_load_dwordx4 v1, s[4:7], s12 offen offset:3072 sc1 lds
    s_add_u32 m0, s13, 4096
    v_exp_f32 v28, v28
    v_mfma_f32_32x32x16_bf16 v[64:79], a[84:87], a[48:51], v[64:79]
    v_exp_f32 v29, v29
    v_cvt_pk_bf16_f32 v82, v24, v25
    v_cvt_pk_bf16_f32 v86, v28, v29
    v_permlane16_swap_b32 v81, v85
    v_mfma_f32_32x32x16_bf16 v[48:63], a[88:91], a[16:19], v[48:63]
    buffer_load_dwordx4 v2, s[4:7], s12 offen offset:0 sc1 lds
    v_exp_f32 v26, v26
    v_exp_f32 v27, v27
    v_mfma_f32_32x32x16_bf16 v[64:79], a[88:91], a[52:55], v[64:79]
    buffer_load_dwordx4 v2, s[4:7], s12 offen offset:1024 sc1 lds
    v_exp_f32 v30, v30
    v_exp_f32 v31, v31
    v_mfma_f32_32x32x16_bf16 v[48:63], a[92:95], a[20:23], v[48:63]
    v_cvt_pk_bf16_f32 v83, v26, v27
    v_cvt_pk_bf16_f32 v87, v30, v31
    v_permlane16_swap_b32 v82, v86
    s_nop 0
    v_permlane16_swap_b32 v83, v87
    v_exp_f32 v32, v32
    v_mfma_f32_32x32x16_bf16 v[64:79], a[92:95], a[56:59], v[64:79]
    buffer_load_dwordx4 v2, s[4:7], s12 offen offset:2048 sc1 lds
    v_exp_f32 v33, v33
    v_exp_f32 v36, v36
    v_mfma_f32_32x32x16_bf16 v[48:63], a[96:99], a[24:27], v[48:63]
    buffer_load_dwordx4 v2, s[4:7], s12 offen offset:3072 sc1 lds
    s_add_u32 m0, s13, 8192
    v_exp_f32 v37, v37
    v_mfma_f32_32x32x16_bf16 v[64:79], a[96:99], a[60:63], v[64:79]
    v_cvt_pk_bf16_f32 v88, v32, v33
    v_cvt_pk_bf16_f32 v92, v36, v37
    v_exp_f32 v34, v34
    v_mfma_f32_32x32x16_bf16 v[48:63], a[100:103], a[28:31], v[48:63]
    buffer_load_dwordx4 v3, s[4:7], s12 offen offset:0 sc1 lds
    v_exp_f32 v35, v35
    v_exp_f32 v38, v38
    v_mfma_f32_32x32x16_bf16 v[64:79], a[100:103], a[64:67], v[64:79]
    buffer_load_dwordx4 v3, s[4:7], s12 offen offset:1024 sc1 lds
    v_exp_f32 v39, v39
    v_cvt_pk_bf16_f32 v89, v34, v35
    v_cvt_pk_bf16_f32 v93, v38, v39
    v_mfma_f32_32x32x16_bf16 v[48:63], a[104:107], a[32:35], v[48:63]
    s_add_u32 s12, s12, 10240
    v_permlane16_swap_b32 v88, v92
    v_exp_f32 v40, v40
    v_exp_f32 v41, v41
    v_mfma_f32_32x32x16_bf16 v[64:79], a[104:107], a[68:71], v[64:79]
    v_add_u32 v10, s14, v6
    v_add_u32 v11, s14, v7
    v_add_u32 v8, s15, v4
    v_add_u32 v9, s15, v5
    v_mfma_f32_16x16x32_bf16 v[96:99], a[108:111], v[80:83], v[96:99]
    v_exp_f32 v44, v44
    v_mfma_f32_16x16x32_bf16 v[136:139], a[108:111], v[84:87], v[136:139]
    v_exp_f32 v45, v45
    v_mfma_f32_16x16x32_bf16 v[100:103], a[112:115], v[80:83], v[100:103]
    ds_read_b64_tr_b16 a[148:149], v10 offset:0
    v_cvt_pk_bf16_f32 v90, v40, v41
    v_mfma_f32_16x16x32_bf16 v[140:143], a[112:115], v[84:87], v[140:143]
    ds_read_b64_tr_b16 a[150:151], v10 offset:5120
    v_cvt_pk_bf16_f32 v94, v44, v45
    v_mfma_f32_16x16x32_bf16 v[104:107], a[116:119], v[80:83], v[104:107]
    ds_read_b64_tr_b16 a[152:153], v11 offset:0
    v_permlane16_swap_b32 v89, v93
    v_mfma_f32_16x16x32_bf16 v[144:147], a[116:119], v[84:87], v[144:147]
    v_exp_f32 v42, v42
    v_mfma_f32_16x16x32_bf16 v[108:111], a[120:123], v[80:83], v[108:111]
    v_exp_f32 v43, v43
    v_mfma_f32_16x16x32_bf16 v[148:151], a[120:123], v[84:87], v[148:151]
    v_exp_f32 v46, v46
    v_mfma_f32_16x16x32_bf16 v[112:115], a[124:127], v[80:83], v[112:115]
    v_exp_f32 v47, v47
    v_mfma_f32_16x16x32_bf16 v[152:155], a[124:127], v[84:87], v[152:155]
    ds_read_b64_tr_b16 a[154:155], v11 offset:5120
    v_cvt_pk_bf16_f32 v91, v42, v43
    v_mfma_f32_16x16x32_bf16 v[116:119], a[128:131], v[80:83], v[116:119]
    ds_read_b64_tr_b16 a[156:157], v10 offset:64
    v_cvt_pk_bf16_f32 v95, v46, v47
    v_mfma_f32_16x16x32_bf16 v[156:159], a[128:131], v[84:87], v[156:159]
    ds_read_b64_tr_b16 a[158:159], v10 offset:5184
    v_permlane16_swap_b32 v90, v94
    v_mfma_f32_16x16x32_bf16 v[120:123], a[132:135], v[80:83], v[120:123]
    ds_read_b64_tr_b16 a[160:161], v11 offset:64
    v_permlane16_swap_b32 v91, v95
    v_mfma_f32_16x16x32_bf16 v[160:163], a[132:135], v[84:87], v[160:163]
    ds_read_b64_tr_b16 a[162:163], v11 offset:5184
    v_add_f32 v134, v134, v16
    v_mfma_f32_16x16x32_bf16 v[124:127], a[136:139], v[80:83], v[124:127]
    ds_read_b64_tr_b16 a[164:165], v10 offset:128
    v_add_f32 v135, v135, v17
    v_mfma_f32_16x16x32_bf16 v[164:167], a[136:139], v[84:87], v[164:167]
    ds_read_b64_tr_b16 a[166:167], v10 offset:5248
    v_add_f32 v134, v134, v20
    v_mfma_f32_16x16x32_bf16 v[128:131], a[140:143], v[80:83], v[128:131]
    ds_read_b64_tr_b16 a[168:169], v11 offset:128
    v_add_f32 v135, v135, v21
    v_mfma_f32_16x16x32_bf16 v[168:171], a[140:143], v[84:87], v[168:171]
    ds_read_b64_tr_b16 a[170:171], v11 offset:5248
    v_add_f32 v134, v134, v18
    v_mfma_f32_16x16x32_bf16 v[176:179], a[108:111], v[88:91], v[176:179]
    ds_read_b64_tr_b16 a[172:173], v10 offset:192
    v_add_f32 v135, v135, v19
    v_mfma_f32_16x16x32_bf16 v[216:219], a[108:111], v[92:95], v[216:219]
    ds_read_b64_tr_b16 a[174:175], v10 offset:5312
    v_add_f32 v134, v134, v22
    v_mfma_f32_16x16x32_bf16 v[180:183], a[112:115], v[88:91], v[180:183]
    ds_read_b64_tr_b16 a[176:177], v11 offset:192
    v_add_f32 v135, v135, v23
    v_mfma_f32_16x16x32_bf16 v[220:223], a[112:115], v[92:95], v[220:223]
    ds_read_b64_tr_b16 a[178:179], v11 offset:5312
    v_add_f32 v134, v134, v24
    v_mfma_f32_16x16x32_bf16 v[184:187], a[116:119], v[88:91], v[184:187]
    ds_read_b64_tr_b16 a[180:181], v10 offset:256
    v_add_f32 v135, v135, v25
    v_mfma_f32_16x16x32_bf16 v[224:227], a[116:119], v[92:95], v[224:227]
    ds_read_b64_tr_b16 a[182:183], v10 offset:5376
    v_add_f32 v134, v134, v28
    v_mfma_f32_16x16x32_bf16 v[188:191], a[120:123], v[88:91], v[188:191]
    ds_read_b128 a[72:75], v8 offset:0
    v_add_f32 v135, v135, v29
    v_mfma_f32_16x16x32_bf16 v[228:231], a[120:123], v[92:95], v[228:231]
    ds_read_b128 a[76:79], v9 offset:0
    v_add_f32 v134, v134, v26
    v_mfma_f32_16x16x32_bf16 v[192:195], a[124:127], v[88:91], v[192:195]
    ds_read_b128 a[80:83], v8 offset:64
    v_add_f32 v135, v135, v27
    v_mfma_f32_16x16x32_bf16 v[232:235], a[124:127], v[92:95], v[232:235]
    ds_read_b128 a[84:87], v9 offset:64
    v_add_f32 v134, v134, v30
    v_mfma_f32_16x16x32_bf16 v[196:199], a[128:131], v[88:91], v[196:199]
    ds_read_b128 a[88:91], v8 offset:128
    v_add_f32 v135, v135, v31
    v_mfma_f32_16x16x32_bf16 v[236:239], a[128:131], v[92:95], v[236:239]
    ds_read_b128 a[92:95], v9 offset:128
    v_add_f32 v214, v214, v32
    v_mfma_f32_16x16x32_bf16 v[200:203], a[132:135], v[88:91], v[200:203]
    ds_read_b128 a[96:99], v8 offset:192
    v_add_f32 v215, v215, v33
    v_mfma_f32_16x16x32_bf16 v[240:243], a[132:135], v[92:95], v[240:243]
    ds_read_b128 a[100:103], v9 offset:192
    v_add_f32 v214, v214, v36
    v_mfma_f32_16x16x32_bf16 v[204:207], a[136:139], v[88:91], v[204:207]
    ds_read_b128 a[104:107], v8 offset:256
    s_mov_b32 s21, s13
    v_add_f32 v215, v215, v37
    v_mfma_f32_16x16x32_bf16 v[244:247], a[136:139], v[92:95], v[244:247]
    s_mov_b32 s13, s14
    v_add_f32 v214, v214, v34
    v_add_f32 v215, v215, v35
    v_mfma_f32_16x16x32_bf16 v[208:211], a[140:143], v[88:91], v[208:211]
    s_mov_b32 s14, s15
    v_add_f32 v214, v214, v38
    v_add_f32 v215, v215, v39
    v_mfma_f32_16x16x32_bf16 v[248:251], a[140:143], v[92:95], v[248:251]
    s_mov_b32 s15, s21
    v_add_f32 v214, v214, v40
    v_add_f32 v215, v215, v41
    v_add_f32 v214, v214, v44
    v_add_f32 v215, v215, v45
    v_add_f32 v214, v214, v42
    v_add_f32 v215, v215, v43
    v_add_f32 v214, v214, v46
    v_add_f32 v215, v215, v47
    s_waitcnt lgkmcnt(0)
    v_mfma_f32_32x32x16_bf16 v[16:31], a[72:75], a[0:3], 0
    s_mov_b32 m0, s77
    v_add_u32 v14, s81, v1
    v_exp_f32 v48, v48
    v_exp_f32 v49, v49
    v_mfma_f32_32x32x16_bf16 v[32:47], a[72:75], a[36:39], 0
    buffer_load_dwordx4 v14, s[4:7], 0 offen sc1 lds
    v_exp_f32 v52, v52
    v_exp_f32 v53, v53
    v_mfma_f32_32x32x16_bf16 v[16:31], a[76:79], a[4:7], v[16:31]
    s_mov_b32 m0, s78
    v_cvt_pk_bf16_f32 v80, v48, v49
    v_cvt_pk_bf16_f32 v84, v52, v53
    v_exp_f32 v50, v50
    v_mfma_f32_32x32x16_bf16 v[32:47], a[76:79], a[40:43], v[32:47]
    v_add_u32 v15, s82, v1
    v_exp_f32 v51, v51
    v_exp_f32 v54, v54
    v_mfma_f32_32x32x16_bf16 v[16:31], a[80:83], a[8:11], v[16:31]
    buffer_load_dwordx4 v15, s[4:7], 0 offen sc1 lds
    v_exp_f32 v55, v55
    v_cvt_pk_bf16_f32 v81, v50, v51
    v_cvt_pk_bf16_f32 v85, v54, v55
    v_mfma_f32_32x32x16_bf16 v[32:47], a[80:83], a[44:47], v[32:47]
    s_mov_b32 m0, s79
    v_permlane16_swap_b32 v80, v84
    v_exp_f32 v56, v56
    v_exp_f32 v57, v57
    v_mfma_f32_32x32x16_bf16 v[16:31], a[84:87], a[12:15], v[16:31]
    v_add_u32 v14, s83, v1
    buffer_load_dwordx4 v14, s[4:7], 0 offen sc1 lds
    v_exp_f32 v60, v60
    v_mfma_f32_32x32x16_bf16 v[32:47], a[84:87], a[48:51], v[32:47]
    s_mov_b32 m0, s80
    v_exp_f32 v61, v61
    v_cvt_pk_bf16_f32 v82, v56, v57
    v_cvt_pk_bf16_f32 v86, v60, v61
    v_permlane16_swap_b32 v81, v85
    v_mfma_f32_32x32x16_bf16 v[16:31], a[88:91], a[16:19], v[16:31]
    v_add_u32 v15, s84, v1
    v_exp_f32 v58, v58
    v_exp_f32 v59, v59
    v_mfma_f32_32x32x16_bf16 v[32:47], a[88:91], a[52:55], v[32:47]
    buffer_load_dwordx4 v15, s[4:7], 0 offen sc1 lds
    v_exp_f32 v62, v62
    v_exp_f32 v63, v63
    v_mfma_f32_32x32x16_bf16 v[16:31], a[92:95], a[20:23], v[16:31]
    buffer_load_dwordx4 a[188:191], v1, s[8:11], s74 offen offset:0 sc1
    v_cvt_pk_bf16_f32 v83, v58, v59
    v_cvt_pk_bf16_f32 v87, v62, v63
    v_permlane16_swap_b32 v82, v86
    s_nop 0
    v_permlane16_swap_b32 v83, v87
    v_mfma_f32_32x32x16_bf16 v[32:47], a[92:95], a[56:59], v[32:47]
    buffer_load_dwordx4 a[192:195], v1, s[8:11], s74 offen offset:1024 sc1
    v_exp_f32 v64, v64
    v_exp_f32 v65, v65
    v_mfma_f32_32x32x16_bf16 v[16:31], a[96:99], a[24:27], v[16:31]
    buffer_load_dwordx4 a[196:199], v1, s[8:11], s74 offen offset:2048 sc1
    buffer_load_dwordx4 a[200:203], v1, s[8:11], s74 offen offset:3072 sc1
    v_exp_f32 v68, v68
    v_exp_f32 v69, v69
    v_mfma_f32_32x32x16_bf16 v[32:47], a[96:99], a[60:63], v[32:47]
    buffer_load_dwordx4 a[204:207], v2, s[8:11], s74 offen sc1
    v_cvt_pk_bf16_f32 v88, v64, v65
    v_cvt_pk_bf16_f32 v92, v68, v69
    v_exp_f32 v66, v66
    v_mfma_f32_32x32x16_bf16 v[16:31], a[100:103], a[28:31], v[16:31]
    buffer_load_dwordx4 a[208:211], v1, s[8:11], s35 offen offset:0 sc1
    v_exp_f32 v67, v67
    v_exp_f32 v70, v70
    v_mfma_f32_32x32x16_bf16 v[32:47], a[100:103], a[64:67], v[32:47]
    buffer_load_dwordx4 a[212:215], v1, s[8:11], s35 offen offset:1024 sc1
    v_exp_f32 v71, v71
    v_cvt_pk_bf16_f32 v89, v66, v67
    v_cvt_pk_bf16_f32 v93, v70, v71
    v_permlane16_swap_b32 v88, v92
    v_mfma_f32_32x32x16_bf16 v[16:31], a[104:107], a[32:35], v[16:31]
    buffer_load_dwordx4 a[216:219], v1, s[8:11], s35 offen offset:2048 sc1
    v_exp_f32 v72, v72
    v_exp_f32 v73, v73
    v_mfma_f32_32x32x16_bf16 v[32:47], a[104:107], a[68:71], v[32:47]
    buffer_load_dwordx4 a[220:223], v1, s[8:11], s35 offen offset:3072 sc1
    v_add_u32 v10, s14, v6
    v_add_u32 v11, s14, v7
    v_add_u32 v8, s15, v4
    v_add_u32 v9, s15, v5
    v_mfma_f32_16x16x32_bf16 v[96:99], a[148:151], v[80:83], v[96:99]
    v_exp_f32 v76, v76
    v_mfma_f32_16x16x32_bf16 v[136:139], a[148:151], v[84:87], v[136:139]
    v_exp_f32 v77, v77
    v_mfma_f32_16x16x32_bf16 v[100:103], a[152:155], v[80:83], v[100:103]
    ds_read_b64_tr_b16 a[108:109], v10 offset:0
    v_cvt_pk_bf16_f32 v90, v72, v73
    v_mfma_f32_16x16x32_bf16 v[140:143], a[152:155], v[84:87], v[140:143]
    ds_read_b64_tr_b16 a[110:111], v10 offset:5120
    v_cvt_pk_bf16_f32 v94, v76, v77
    v_mfma_f32_16x16x32_bf16 v[104:107], a[156:159], v[80:83], v[104:107]
    ds_read_b64_tr_b16 a[112:113], v11 offset:0
    v_permlane16_swap_b32 v89, v93
    v_mfma_f32_16x16x32_bf16 v[144:147], a[156:159], v[84:87], v[144:147]
    v_exp_f32 v74, v74
    v_mfma_f32_16x16x32_bf16 v[108:111], a[160:163], v[80:83], v[108:111]
    v_exp_f32 v75, v75
    v_mfma_f32_16x16x32_bf16 v[148:151], a[160:163], v[84:87], v[148:151]
    v_exp_f32 v78, v78
    v_mfma_f32_16x16x32_bf16 v[112:115], a[164:167], v[80:83], v[112:115]
    v_exp_f32 v79, v79
    v_mfma_f32_16x16x32_bf16 v[152:155], a[164:167], v[84:87], v[152:155]
    ds_read_b64_tr_b16 a[114:115], v11 offset:5120
    v_cvt_pk_bf16_f32 v91, v74, v75
    v_mfma_f32_16x16x32_bf16 v[116:119], a[168:171], v[80:83], v[116:119]
    ds_read_b64_tr_b16 a[116:117], v10 offset:64
    v_cvt_pk_bf16_f32 v95, v78, v79
    v_mfma_f32_16x16x32_bf16 v[156:159], a[168:171], v[84:87], v[156:159]
    ds_read_b64_tr_b16 a[118:119], v10 offset:5184
    v_permlane16_swap_b32 v90, v94
    v_mfma_f32_16x16x32_bf16 v[120:123], a[172:175], v[80:83], v[120:123]
    ds_read_b64_tr_b16 a[120:121], v11 offset:64
    v_permlane16_swap_b32 v91, v95
    v_mfma_f32_16x16x32_bf16 v[160:163], a[172:175], v[84:87], v[160:163]
    ds_read_b64_tr_b16 a[122:123], v11 offset:5184
    ds_read_b64_tr_b16 a[124:125], v10 offset:128
    v_mfma_f32_16x16x32_bf16 v[124:127], a[176:179], v[80:83], v[124:127]
    ds_read_b64_tr_b16 a[126:127], v10 offset:5248
    v_fma_f32 v134, v48, s94, v134
    v_mfma_f32_16x16x32_bf16 v[164:167], a[176:179], v[84:87], v[164:167]
    ds_read_b64_tr_b16 a[128:129], v11 offset:128
    v_fma_f32 v135, v49, s94, v135
    v_mfma_f32_16x16x32_bf16 v[128:131], a[180:183], v[80:83], v[128:131]
    ds_read_b64_tr_b16 a[130:131], v11 offset:5248
    ds_read_b64_tr_b16 a[132:133], v10 offset:192
    v_mfma_f32_16x16x32_bf16 v[168:171], a[180:183], v[84:87], v[168:171]
    ds_read_b64_tr_b16 a[134:135], v10 offset:5312
    v_fma_f32 v134, v52, s94, v134
    v_mfma_f32_16x16x32_bf16 v[176:179], a[148:151], v[88:91], v[176:179]
    ds_read_b64_tr_b16 a[136:137], v11 offset:192
    v_fma_f32 v135, v53, s94, v135
    v_mfma_f32_16x16x32_bf16 v[216:219], a[148:151], v[92:95], v[216:219]
    ds_read_b64_tr_b16 a[138:139], v11 offset:5312
    v_fma_f32 v134, v50, s94, v134
    v_mfma_f32_16x16x32_bf16 v[180:183], a[152:155], v[88:91], v[180:183]
    ds_read_b64_tr_b16 a[140:141], v10 offset:256
    ds_read_b64_tr_b16 a[142:143], v10 offset:5376
    v_mfma_f32_16x16x32_bf16 v[220:223], a[152:155], v[92:95], v[220:223]
    ds_read_b64_tr_b16 a[144:145], v11 offset:256
    v_fma_f32 v135, v51, s94, v135
    v_mfma_f32_16x16x32_bf16 v[184:187], a[156:159], v[88:91], v[184:187]
    ds_read_b64_tr_b16 a[146:147], v11 offset:5376
    v_fma_f32 v134, v54, s94, v134
    v_mfma_f32_16x16x32_bf16 v[224:227], a[156:159], v[92:95], v[224:227]
    s_waitcnt vmcnt(13)
    ds_read_b128 a[72:75], v8 offset:0
    v_fma_f32 v135, v55, s94, v135
    v_mfma_f32_16x16x32_bf16 v[188:191], a[160:163], v[88:91], v[188:191]
    ds_read_b128 a[76:79], v9 offset:0
    ds_read_b128 a[80:83], v8 offset:64
    v_mfma_f32_16x16x32_bf16 v[228:231], a[160:163], v[92:95], v[228:231]
    ds_read_b128 a[84:87], v9 offset:64
    v_fma_f32 v134, v56, s94, v134
    v_mfma_f32_16x16x32_bf16 v[192:195], a[164:167], v[88:91], v[192:195]
    ds_read_b128 a[88:91], v8 offset:128
    v_fma_f32 v135, v57, s94, v135
    v_mfma_f32_16x16x32_bf16 v[232:235], a[164:167], v[92:95], v[232:235]
    ds_read_b128 a[92:95], v9 offset:128
    v_fma_f32 v134, v60, s94, v134
    v_mfma_f32_16x16x32_bf16 v[196:199], a[168:171], v[88:91], v[196:199]
    ds_read_b128 a[96:99], v8 offset:192
    ds_read_b128 a[100:103], v9 offset:192
    v_mfma_f32_16x16x32_bf16 v[236:239], a[168:171], v[92:95], v[236:239]
    ds_read_b128 a[104:107], v8 offset:256
    v_fma_f32 v135, v61, s94, v135
    v_mfma_f32_16x16x32_bf16 v[200:203], a[172:175], v[88:91], v[200:203]
    s_add_u32 m0, s89, 0
    v_fma_f32 v134, v58, s94, v134
    v_fma_f32 v135, v59, s94, v135
    v_mfma_f32_16x16x32_bf16 v[240:243], a[172:175], v[92:95], v[240:243]
    buffer_load_dwordx4 v1, s[8:11], s87 offen offset:0 sc1 lds
    v_fma_f32 v134, v62, s94, v134
    v_mfma_f32_16x16x32_bf16 v[204:207], a[176:179], v[88:91], v[204:207]
    buffer_load_dwordx4 v1, s[8:11], s87 offen offset:1024 sc1 lds
    buffer_load_dwordx4 v1, s[8:11], s87 offen offset:2048 sc1 lds
    s_mov_b32 s21, s13
    v_mfma_f32_16x16x32_bf16 v[244:247], a[176:179], v[92:95], v[244:247]
    buffer_load_dwordx4 v1, s[8:11], s87 offen offset:3072 sc1 lds
    s_mov_b32 s13, s14
    v_fma_f32 v135, v63, s94, v135
    v_mfma_f32_16x16x32_bf16 v[208:211], a[180:183], v[88:91], v[208:211]
    s_add_u32 m0, s89, 4096
    s_mov_b32 s14, s15
    v_fma_f32 v214, v64, s94, v214
    v_fma_f32 v215, v65, s94, v215
    v_mfma_f32_16x16x32_bf16 v[248:251], a[180:183], v[92:95], v[248:251]
    buffer_load_dwordx4 v2, s[8:11], s87 offen sc1 lds
    s_mov_b32 s15, s21
    v_fma_f32 v214, v68, s94, v214
    v_fma_f32 v215, v69, s94, v215
    v_fma_f32 v214, v66, s94, v214
    v_fma_f32 v215, v67, s94, v215
    v_fma_f32 v214, v70, s94, v214
    v_fma_f32 v215, v71, s94, v215
    v_fma_f32 v214, v72, s94, v214
    v_fma_f32 v215, v73, s94, v215
    v_fma_f32 v214, v76, s94, v214
    v_fma_f32 v215, v77, s94, v215
    v_fma_f32 v214, v74, s94, v214
    v_fma_f32 v215, v75, s94, v215
    v_fma_f32 v214, v78, s94, v214
    v_fma_f32 v215, v79, s94, v215
    v_add_f32 v134, v134, v135
    v_cndmask_b32 v132, 0, v134, s[90:91]
    v_cndmask_b32 v172, 0, v134, s[92:93]
    v_add_f32 v214, v214, v215
    v_cndmask_b32 v212, 0, v214, s[90:91]
    v_cndmask_b32 v252, 0, v214, s[92:93]
    v_add_u32 v10, s14, v6
    v_add_u32 v11, s14, v7
    s_mul_i32 s3, s19, 10240
    s_waitcnt lgkmcnt(0)
    v_mfma_f32_32x32x16_bf16 v[48:63], a[72:75], a[0:3], 0
    ds_read_b64_tr_b16 a[148:149], v10 offset:0
    ds_read_b64_tr_b16 a[150:151], v10 offset:5120
    buffer_load_dwordx4 a[224:227], v2, s[8:11], s35 offen sc1
    v_add_u32 v12, s3, v1
    v_add_u32 v13, 81920, v12
    v_mfma_f32_32x32x16_bf16 v[64:79], a[72:75], a[36:39], 0
    ds_read_b64_tr_b16 a[152:153], v11 offset:0
    buffer_load_dwordx4 a[228:231], v1, s[8:11], s75 offen offset:0 sc1
    v_exp_f32 v16, v16
    v_exp_f32 v17, v17
    v_mfma_f32_32x32x16_bf16 v[48:63], a[76:79], a[4:7], v[48:63]
    ds_read_b64_tr_b16 a[154:155], v11 offset:5120
    buffer_load_dwordx4 a[232:235], v1, s[8:11], s75 offen offset:1024 sc1
    v_exp_f32 v20, v20
    v_exp_f32 v21, v21
    v_mfma_f32_32x32x16_bf16 v[64:79], a[76:79], a[40:43], v[64:79]
    ds_read_b64_tr_b16 a[156:157], v10 offset:64
    v_cvt_pk_bf16_f32 v80, v16, v17
    v_cvt_pk_bf16_f32 v84, v20, v21
    v_exp_f32 v18, v18
    v_mfma_f32_32x32x16_bf16 v[48:63], a[80:83], a[8:11], v[48:63]
    ds_read_b64_tr_b16 a[158:159], v10 offset:5184
    buffer_load_dwordx4 a[236:239], v1, s[8:11], s75 offen offset:2048 sc1
    v_exp_f32 v19, v19
    v_exp_f32 v22, v22
    v_mfma_f32_32x32x16_bf16 v[64:79], a[80:83], a[44:47], v[64:79]
    ds_read_b64_tr_b16 a[160:161], v11 offset:64
    buffer_load_dwordx4 a[240:243], v1, s[8:11], s75 offen offset:3072 sc1
    v_exp_f32 v23, v23
    v_cvt_pk_bf16_f32 v81, v18, v19
    v_mfma_f32_32x32x16_bf16 v[48:63], a[84:87], a[12:15], v[48:63]
    ds_read_b64_tr_b16 a[162:163], v11 offset:5184
    ds_read_b64_tr_b16 a[164:165], v10 offset:128
    buffer_load_dwordx4 a[244:247], v2, s[8:11], s75 offen sc1
    v_cvt_pk_bf16_f32 v85, v22, v23
    v_permlane16_swap_b32 v80, v84
    v_mfma_f32_32x32x16_bf16 v[64:79], a[84:87], a[48:51], v[64:79]
    ds_read_b64_tr_b16 a[166:167], v10 offset:5248
    v_exp_f32 v24, v24
    v_exp_f32 v25, v25
    v_exp_f32 v28, v28
    v_mfma_f32_32x32x16_bf16 v[48:63], a[88:91], a[16:19], v[48:63]
    ds_read_b64_tr_b16 a[168:169], v11 offset:128
    s_add_u32 m0, s89, 40960
    v_exp_f32 v29, v29
    v_cvt_pk_bf16_f32 v82, v24, v25
    v_mfma_f32_32x32x16_bf16 v[64:79], a[88:91], a[52:55], v[64:79]
    ds_read_b64_tr_b16 a[170:171], v11 offset:5248
    buffer_load_dwordx4 v1, s[8:11], s88 offen offset:0 sc1 lds
    v_cvt_pk_bf16_f32 v86, v28, v29
    v_permlane16_swap_b32 v81, v85
    v_exp_f32 v26, v26
    v_mfma_f32_32x32x16_bf16 v[48:63], a[92:95], a[20:23], v[48:63]
    ds_read_b64_tr_b16 a[172:173], v10 offset:192
    v_exp_f32 v27, v27
    v_exp_f32 v30, v30
    v_mfma_f32_32x32x16_bf16 v[64:79], a[92:95], a[56:59], v[64:79]
    ds_read_b64_tr_b16 a[174:175], v10 offset:5312
    buffer_load_dwordx4 v1, s[8:11], s88 offen offset:1024 sc1 lds
    v_exp_f32 v31, v31
    v_cvt_pk_bf16_f32 v83, v26, v27
    v_cvt_pk_bf16_f32 v87, v30, v31
    v_mfma_f32_32x32x16_bf16 v[48:63], a[96:99], a[24:27], v[48:63]
    ds_read_b64_tr_b16 a[176:177], v11 offset:192
    ds_read_b64_tr_b16 a[178:179], v11 offset:5312
    buffer_load_dwordx4 v1, s[8:11], s88 offen offset:2048 sc1 lds
    v_permlane16_swap_b32 v82, v86
    v_permlane16_swap_b32 v83, v87
    v_mfma_f32_32x32x16_bf16 v[64:79], a[96:99], a[60:63], v[64:79]
    ds_read_b64_tr_b16 a[180:181], v10 offset:256
    buffer_load_dwordx4 v1, s[8:11], s88 offen offset:3072 sc1 lds
    v_exp_f32 v32, v32
    v_exp_f32 v33, v33
    v_mfma_f32_32x32x16_bf16 v[48:63], a[100:103], a[28:31], v[48:63]
    ds_read_b64_tr_b16 a[182:183], v10 offset:5376
    v_exp_f32 v36, v36
    v_exp_f32 v37, v37
    v_mfma_f32_32x32x16_bf16 v[64:79], a[100:103], a[64:67], v[64:79]
    ds_read_b64_tr_b16 a[184:185], v11 offset:256
    s_add_u32 m0, s89, 45056
    v_cvt_pk_bf16_f32 v88, v32, v33
    v_cvt_pk_bf16_f32 v92, v36, v37
    v_exp_f32 v34, v34
    v_mfma_f32_32x32x16_bf16 v[48:63], a[104:107], a[32:35], v[48:63]
    ds_read_b64_tr_b16 a[186:187], v11 offset:5376
    buffer_load_dwordx4 v2, s[8:11], s88 offen sc1 lds
    v_exp_f32 v35, v35
    v_exp_f32 v38, v38
    v_mfma_f32_32x32x16_bf16 v[64:79], a[104:107], a[68:71], v[64:79]
    v_exp_f32 v39, v39
    v_cvt_pk_bf16_f32 v89, v34, v35
    v_cvt_pk_bf16_f32 v93, v38, v39
    v_permlane16_swap_b32 v88, v92
    v_mfma_f32_16x16x32_bf16 v[96:99], a[108:111], v[80:83], v[96:99]
    s_nop 1
    v_exp_f32 v48, v48
    v_mfma_f32_16x16x32_bf16 v[136:139], a[108:111], v[84:87], v[136:139]
    v_exp_f32 v49, v49
    v_mfma_f32_16x16x32_bf16 v[100:103], a[112:115], v[80:83], v[100:103]
    v_exp_f32 v52, v52
    v_mfma_f32_16x16x32_bf16 v[140:143], a[112:115], v[84:87], v[140:143]
    v_exp_f32 v53, v53
    v_mfma_f32_16x16x32_bf16 v[104:107], a[116:119], v[80:83], v[104:107]
    v_cvt_pk_bf16_f32 v16, v48, v49
    v_cvt_pk_bf16_f32 v20, v52, v53
    v_mfma_f32_16x16x32_bf16 v[144:147], a[116:119], v[84:87], v[144:147]
    v_exp_f32 v50, v50
    v_mfma_f32_16x16x32_bf16 v[108:111], a[120:123], v[80:83], v[108:111]
    v_exp_f32 v51, v51
    v_mfma_f32_16x16x32_bf16 v[148:151], a[120:123], v[84:87], v[148:151]
    v_exp_f32 v54, v54
    v_mfma_f32_16x16x32_bf16 v[112:115], a[124:127], v[80:83], v[112:115]
    v_exp_f32 v55, v55
    v_mfma_f32_16x16x32_bf16 v[152:155], a[124:127], v[84:87], v[152:155]
    v_cvt_pk_bf16_f32 v17, v50, v51
    v_cvt_pk_bf16_f32 v21, v54, v55
    v_mfma_f32_16x16x32_bf16 v[116:119], a[128:131], v[80:83], v[116:119]
    v_permlane16_swap_b32 v16, v20
    v_mfma_f32_16x16x32_bf16 v[156:159], a[128:131], v[84:87], v[156:159]
    v_exp_f32 v56, v56
    v_mfma_f32_16x16x32_bf16 v[120:123], a[132:135], v[80:83], v[120:123]
    v_exp_f32 v57, v57
    v_mfma_f32_16x16x32_bf16 v[160:163], a[132:135], v[84:87], v[160:163]
    v_exp_f32 v60, v60
    v_mfma_f32_16x16x32_bf16 v[124:127], a[136:139], v[80:83], v[124:127]
    v_exp_f32 v61, v61
    v_mfma_f32_16x16x32_bf16 v[164:167], a[136:139], v[84:87], v[164:167]
    v_cvt_pk_bf16_f32 v18, v56, v57
    v_cvt_pk_bf16_f32 v22, v60, v61
    v_mfma_f32_16x16x32_bf16 v[128:131], a[140:143], v[80:83], v[128:131]
    v_permlane16_swap_b32 v17, v21
    v_mfma_f32_16x16x32_bf16 v[168:171], a[140:143], v[84:87], v[168:171]
    v_exp_f32 v58, v58
    v_mfma_f32_16x16x32_bf16 v[132:135], a[144:147], v[80:83], v[132:135]
    v_exp_f32 v59, v59
    v_mfma_f32_16x16x32_bf16 v[172:175], a[144:147], v[84:87], v[172:175]
    v_exp_f32 v62, v62
    v_exp_f32 v63, v63
    v_cvt_pk_bf16_f32 v19, v58, v59
    v_cvt_pk_bf16_f32 v23, v62, v63
    v_permlane16_swap_b32 v18, v22
    s_nop 0
    v_permlane16_swap_b32 v19, v23
    s_waitcnt lgkmcnt(15)
    s_nop 0
    v_mfma_f32_16x16x32_bf16 v[96:99], a[148:151], v[16:19], v[96:99]
    buffer_load_dwordx4 a[0:3], v1, s[8:11], s36 offen offset:0 sc1
    v_mfma_f32_16x16x32_bf16 v[136:139], a[148:151], v[20:23], v[136:139]
    v_exp_f32 v40, v40
    v_mfma_f32_16x16x32_bf16 v[100:103], a[152:155], v[16:19], v[100:103]
    v_exp_f32 v41, v41
    v_mfma_f32_16x16x32_bf16 v[140:143], a[152:155], v[20:23], v[140:143]
    v_exp_f32 v44, v44
    s_waitcnt lgkmcnt(14)
    v_mfma_f32_16x16x32_bf16 v[104:107], a[156:159], v[16:19], v[104:107]
    buffer_load_dwordx4 a[4:7], v1, s[8:11], s36 offen offset:1024 sc1
    v_mfma_f32_16x16x32_bf16 v[144:147], a[156:159], v[20:23], v[144:147]
    v_cvt_pk_bf16_f32 v96, v96, v97
    v_cvt_pk_bf16_f32 v97, v98, v99
    s_waitcnt lgkmcnt(12)
    v_mfma_f32_16x16x32_bf16 v[108:111], a[160:163], v[16:19], v[108:111]
    v_cvt_pk_bf16_f32 v98, v100, v101
    v_cvt_pk_bf16_f32 v99, v102, v103
    v_mfma_f32_16x16x32_bf16 v[148:151], a[160:163], v[20:23], v[148:151]
    ds_write_b128 v12, v[96:99] offset:0
    v_cvt_pk_bf16_f32 v136, v136, v137
    s_waitcnt lgkmcnt(11)
    v_mfma_f32_16x16x32_bf16 v[112:115], a[164:167], v[16:19], v[112:115]
    buffer_load_dwordx4 a[8:11], v1, s[8:11], s36 offen offset:2048 sc1
    v_cvt_pk_bf16_f32 v137, v138, v139
    v_mfma_f32_16x16x32_bf16 v[152:155], a[164:167], v[20:23], v[152:155]
    v_cvt_pk_bf16_f32 v138, v140, v141
    v_cvt_pk_bf16_f32 v139, v142, v143
    s_waitcnt lgkmcnt(9)
    v_mfma_f32_16x16x32_bf16 v[116:119], a[168:171], v[16:19], v[116:119]
    ds_write_b128 v12, v[136:139] offset:40960
    v_cvt_pk_bf16_f32 v104, v104, v105
    v_mfma_f32_16x16x32_bf16 v[156:159], a[168:171], v[20:23], v[156:159]
    v_cvt_pk_bf16_f32 v105, v106, v107
    v_cvt_pk_bf16_f32 v106, v108, v109
    s_waitcnt lgkmcnt(8)
    v_mfma_f32_16x16x32_bf16 v[120:123], a[172:175], v[16:19], v[120:123]
    buffer_load_dwordx4 a[12:15], v1, s[8:11], s36 offen offset:3072 sc1
    v_cvt_pk_bf16_f32 v107, v110, v111
    v_mfma_f32_16x16x32_bf16 v[160:163], a[172:175], v[20:23], v[160:163]
    ds_write_b128 v12, v[104:107] offset:1024
    v_cvt_pk_bf16_f32 v144, v144, v145
    s_waitcnt lgkmcnt(7)
    v_mfma_f32_16x16x32_bf16 v[124:127], a[176:179], v[16:19], v[124:127]
    v_cvt_pk_bf16_f32 v145, v146, v147
    v_cvt_pk_bf16_f32 v146, v148, v149
    v_mfma_f32_16x16x32_bf16 v[164:167], a[176:179], v[20:23], v[164:167]
    v_cvt_pk_bf16_f32 v147, v150, v151
    s_waitcnt lgkmcnt(5)
    v_mfma_f32_16x16x32_bf16 v[128:131], a[180:183], v[16:19], v[128:131]
    buffer_load_dwordx4 a[16:19], v2, s[8:11], s36 offen offset:0 sc1
    v_mfma_f32_16x16x32_bf16 v[168:171], a[180:183], v[20:23], v[168:171]
    ds_write_b128 v12, v[144:147] offset:41984
    v_cvt_pk_bf16_f32 v112, v112, v113
    s_waitcnt lgkmcnt(4)
    v_mfma_f32_16x16x32_bf16 v[132:135], a[184:187], v[16:19], v[132:135]
    v_cvt_pk_bf16_f32 v113, v114, v115
    v_cvt_pk_bf16_f32 v114, v116, v117
    v_mfma_f32_16x16x32_bf16 v[172:175], a[184:187], v[20:23], v[172:175]
    v_cvt_pk_bf16_f32 v115, v118, v119
    v_exp_f32 v45, v45
    v_cvt_pk_bf16_f32 v90, v40, v41
    v_cvt_pk_bf16_f32 v94, v44, v45
    v_permlane16_swap_b32 v89, v93
    v_exp_f32 v42, v42
    v_exp_f32 v43, v43
    v_exp_f32 v46, v46
    v_exp_f32 v47, v47
    v_cvt_pk_bf16_f32 v91, v42, v43
    v_cvt_pk_bf16_f32 v95, v46, v47
    v_permlane16_swap_b32 v90, v94
    s_nop 0
    v_permlane16_swap_b32 v91, v95
    s_nop 1
    v_mfma_f32_16x16x32_bf16 v[176:179], a[108:111], v[88:91], v[176:179]
    buffer_load_dwordx4 a[20:23], v2, s[8:11], s36 offen offset:1024 sc1
    v_mfma_f32_16x16x32_bf16 v[216:219], a[108:111], v[92:95], v[216:219]
    ds_write_b128 v12, v[112:115] offset:2048
    v_cvt_pk_bf16_f32 v152, v152, v153
    v_mfma_f32_16x16x32_bf16 v[180:183], a[112:115], v[88:91], v[180:183]
    v_cvt_pk_bf16_f32 v153, v154, v155
    v_cvt_pk_bf16_f32 v154, v156, v157
    v_mfma_f32_16x16x32_bf16 v[220:223], a[112:115], v[92:95], v[220:223]
    v_cvt_pk_bf16_f32 v155, v158, v159
    v_mfma_f32_16x16x32_bf16 v[184:187], a[116:119], v[88:91], v[184:187]
    ds_write_b128 v12, v[152:155] offset:43008
    v_cvt_pk_bf16_f32 v120, v120, v121
    v_mfma_f32_16x16x32_bf16 v[224:227], a[116:119], v[92:95], v[224:227]
    buffer_load_dwordx4 a[24:27], v2, s[8:11], s36 offen offset:2048 sc1
    v_cvt_pk_bf16_f32 v121, v122, v123
    v_mfma_f32_16x16x32_bf16 v[188:191], a[120:123], v[88:91], v[188:191]
    v_cvt_pk_bf16_f32 v122, v124, v125
    v_cvt_pk_bf16_f32 v123, v126, v127
    v_mfma_f32_16x16x32_bf16 v[228:231], a[120:123], v[92:95], v[228:231]
    ds_write_b128 v12, v[120:123] offset:3072
    v_cvt_pk_bf16_f32 v160, v160, v161
    v_mfma_f32_16x16x32_bf16 v[192:195], a[124:127], v[88:91], v[192:195]
    v_cvt_pk_bf16_f32 v161, v162, v163
    v_cvt_pk_bf16_f32 v162, v164, v165
    v_mfma_f32_16x16x32_bf16 v[232:235], a[124:127], v[92:95], v[232:235]
    buffer_load_dwordx4 a[28:31], v2, s[8:11], s36 offen offset:3072 sc1
    v_cvt_pk_bf16_f32 v163, v166, v167
    v_mfma_f32_16x16x32_bf16 v[196:199], a[128:131], v[88:91], v[196:199]
    ds_write_b128 v12, v[160:163] offset:44032
    v_cvt_pk_bf16_f32 v128, v128, v129
    v_mfma_f32_16x16x32_bf16 v[236:239], a[128:131], v[92:95], v[236:239]
    v_cvt_pk_bf16_f32 v129, v130, v131
    v_and_b32 v130, 0xffff0000, v132
    v_mfma_f32_16x16x32_bf16 v[200:203], a[132:135], v[88:91], v[200:203]
    v_sub_f32 v133, v132, v130
    v_cvt_pk_bf16_f32 v130, v130, v133
    v_mfma_f32_16x16x32_bf16 v[240:243], a[132:135], v[92:95], v[240:243]
    buffer_load_dwordx4 a[32:35], v3, s[8:11], s36 offen offset:0 sc1
    v_mov_b32 v131, 0
    v_mfma_f32_16x16x32_bf16 v[204:207], a[136:139], v[88:91], v[204:207]
    ds_write_b128 v12, v[128:131] offset:4096
    v_cvt_pk_bf16_f32 v168, v168, v169
    v_mfma_f32_16x16x32_bf16 v[244:247], a[136:139], v[92:95], v[244:247]
    v_cvt_pk_bf16_f32 v169, v170, v171
    v_and_b32 v170, 0xffff0000, v172
    v_mfma_f32_16x16x32_bf16 v[208:211], a[140:143], v[88:91], v[208:211]
    v_sub_f32 v173, v172, v170
    v_cvt_pk_bf16_f32 v170, v170, v173
    v_mfma_f32_16x16x32_bf16 v[248:251], a[140:143], v[92:95], v[248:251]
    buffer_load_dwordx4 a[36:39], v1, s[8:11], s37 offen offset:0 sc1
    v_mov_b32 v171, 0
    v_mfma_f32_16x16x32_bf16 v[212:215], a[144:147], v[88:91], v[212:215]
    ds_write_b128 v12, v[168:171] offset:45056
    v_mfma_f32_16x16x32_bf16 v[252:255], a[144:147], v[92:95], v[252:255]
    v_exp_f32 v64, v64
    v_exp_f32 v65, v65
    v_exp_f32 v68, v68
    v_exp_f32 v69, v69
    v_cvt_pk_bf16_f32 v32, v64, v65
    v_cvt_pk_bf16_f32 v36, v68, v69
    v_exp_f32 v66, v66
    v_exp_f32 v67, v67
    v_exp_f32 v70, v70
    v_exp_f32 v71, v71
    v_cvt_pk_bf16_f32 v33, v66, v67
    v_cvt_pk_bf16_f32 v37, v70, v71
    v_permlane16_swap_b32 v32, v36
    v_exp_f32 v72, v72
    v_exp_f32 v73, v73
    v_exp_f32 v76, v76
    v_exp_f32 v77, v77
    v_cvt_pk_bf16_f32 v34, v72, v73
    v_cvt_pk_bf16_f32 v38, v76, v77
    v_permlane16_swap_b32 v33, v37
    v_exp_f32 v74, v74
    v_exp_f32 v75, v75
    v_exp_f32 v78, v78
    v_exp_f32 v79, v79
    v_cvt_pk_bf16_f32 v35, v74, v75
    v_cvt_pk_bf16_f32 v39, v78, v79
    v_permlane16_swap_b32 v34, v38
    s_nop 0
    v_permlane16_swap_b32 v35, v39
    s_nop 1
    v_mfma_f32_16x16x32_bf16 v[176:179], a[148:151], v[32:35], v[176:179]
    v_mfma_f32_16x16x32_bf16 v[180:183], a[152:155], v[32:35], v[180:183]
    buffer_load_dwordx4 a[40:43], v1, s[8:11], s37 offen offset:1024 sc1
    v_mfma_f32_16x16x32_bf16 v[184:187], a[156:159], v[32:35], v[184:187]
    v_mfma_f32_16x16x32_bf16 v[188:191], a[160:163], v[32:35], v[188:191]
    v_mfma_f32_16x16x32_bf16 v[192:195], a[164:167], v[32:35], v[192:195]
    s_nop 2
    v_cvt_pk_bf16_f32 v176, v176, v177
    v_cvt_pk_bf16_f32 v177, v178, v179
    v_mfma_f32_16x16x32_bf16 v[196:199], a[168:171], v[32:35], v[196:199]
    buffer_load_dwordx4 a[44:47], v1, s[8:11], s37 offen offset:2048 sc1
    v_cvt_pk_bf16_f32 v178, v180, v181
    v_mfma_f32_16x16x32_bf16 v[200:203], a[172:175], v[32:35], v[200:203]
    v_cvt_pk_bf16_f32 v179, v182, v183
    ds_write_b128 v13, v[176:179] offset:0
    v_mfma_f32_16x16x32_bf16 v[204:207], a[176:179], v[32:35], v[204:207]
    v_cvt_pk_bf16_f32 v184, v184, v185
    v_cvt_pk_bf16_f32 v185, v186, v187
    v_mfma_f32_16x16x32_bf16 v[208:211], a[180:183], v[32:35], v[208:211]
    v_cvt_pk_bf16_f32 v186, v188, v189
    v_cvt_pk_bf16_f32 v187, v190, v191
    v_mfma_f32_16x16x32_bf16 v[212:215], a[184:187], v[32:35], v[212:215]
    ds_write_b128 v13, v[184:187] offset:1024
    v_cvt_pk_bf16_f32 v192, v192, v193
    v_mfma_f32_16x16x32_bf16 v[216:219], a[148:151], v[36:39], v[216:219]
    v_cvt_pk_bf16_f32 v193, v194, v195
    v_cvt_pk_bf16_f32 v194, v196, v197
    v_mfma_f32_16x16x32_bf16 v[220:223], a[152:155], v[36:39], v[220:223]
    v_cvt_pk_bf16_f32 v195, v198, v199
    v_mfma_f32_16x16x32_bf16 v[224:227], a[156:159], v[36:39], v[224:227]
    ds_write_b128 v13, v[192:195] offset:2048
    v_cvt_pk_bf16_f32 v200, v200, v201
    v_mfma_f32_16x16x32_bf16 v[228:231], a[160:163], v[36:39], v[228:231]
    v_cvt_pk_bf16_f32 v201, v202, v203
    v_cvt_pk_bf16_f32 v202, v204, v205
    v_mfma_f32_16x16x32_bf16 v[232:235], a[164:167], v[36:39], v[232:235]
    v_cvt_pk_bf16_f32 v203, v206, v207
    v_mfma_f32_16x16x32_bf16 v[236:239], a[168:171], v[36:39], v[236:239]
    ds_write_b128 v13, v[200:203] offset:3072
    v_cvt_pk_bf16_f32 v208, v208, v209
    v_mfma_f32_16x16x32_bf16 v[240:243], a[172:175], v[36:39], v[240:243]
    v_cvt_pk_bf16_f32 v209, v210, v211
    v_and_b32 v210, 0xffff0000, v212
    v_mfma_f32_16x16x32_bf16 v[244:247], a[176:179], v[36:39], v[244:247]
    v_sub_f32 v213, v212, v210
    v_cvt_pk_bf16_f32 v210, v210, v213
    v_mfma_f32_16x16x32_bf16 v[248:251], a[180:183], v[36:39], v[248:251]
    v_mov_b32 v211, 0
    ds_write_b128 v13, v[208:211] offset:4096
    v_mfma_f32_16x16x32_bf16 v[252:255], a[184:187], v[36:39], v[252:255]
K_JOIN:
    s_add_u32 s3, s19, 1
    s_and_b32 s3, s3, 3
    s_mul_i32 s3, s3, 10240
    s_add_u32 s3, s3, 81920
    v_add_u32 v12, s3, v1
    s_add_u32 s3, s19, 2
    s_and_b32 s3, s3, 3
    s_mul_i32 s3, s3, 10240
    s_add_u32 s3, s3, 40960
    v_add_u32 v13, s3, v1
    s_add_u32 s3, s19, 3
    s_and_b32 s3, s3, 3
    s_mul_i32 s3, s3, 10240
    s_add_u32 s3, s3, 0
    v_add_u32 v14, s3, v1
    v_and_b32 v82, 3, v0
    v_mov_b32 v83, 0x3f80
    v_mov_b32 v84, 0x3f800000
    s_mov_b32 s96, 0x00f0000f
    s_mov_b32 s97, 0xf0000f00
    v_mov_b32 v208, 0
    v_mov_b32 v209, 0
    v_mov_b32 v212, 0
    v_mov_b32 v213, 0
    v_cmp_eq_u32 vcc, 0, v82
    s_nop 1
    v_cndmask_b32 v210, 0, v83, vcc
    v_cmp_eq_u32 vcc, 1, v82
    s_nop 1
    v_cndmask_b32 v210, v210, v84, vcc
    v_cndmask_b32 v210, 0, v210, s[96:97]
    v_cmp_eq_u32 vcc, 2, v82
    s_nop 1
    v_cndmask_b32 v211, 0, v83, vcc
    v_cmp_eq_u32 vcc, 3, v82
    s_nop 1
    v_cndmask_b32 v211, v211, v84, vcc
    v_cndmask_b32 v211, 0, v211, s[96:97]
    v_and_b32 v9, 15, v0
    v_lshrrev_b32 v10, 4, v0
    v_bfe_u32 v11, v0, 2, 2
    v_mul_u32_u24 v85, 320, v9
    v_xor_b32 v86, 2, v11
    v_xor_b32 v86, v86, v10
    v_lshl_add_u32 v86, v86, 4, v85
    v_add_u32 v86, 148480, v86
    v_xor_b32 v87, v11, v10
    v_lshl_add_u32 v87, v87, 4, v85
    v_add_u32 v87, 148480, v87
    s_waitcnt vmcnt(37) lgkmcnt(0)
    s_barrier
    ds_read_b128 v[16:19], v12 offset:0
    ds_read_b128 v[20:23], v12 offset:1024
    ds_read_b128 v[24:27], v12 offset:2048
    ds_read_b128 v[28:31], v12 offset:3072
    ds_read_b128 v[32:35], v12 offset:4096
    ds_read_b128 v[36:39], v13 offset:0
    ds_read_b128 v[40:43], v13 offset:1024
    ds_read_b128 v[44:47], v13 offset:2048
    ds_read_b128 v[48:51], v13 offset:3072
    ds_read_b128 v[52:55], v13 offset:4096
    ds_read_b128 v[56:59], v14 offset:0
    ds_read_b128 v[60:63], v14 offset:1024
    ds_read_b128 v[64:67], v14 offset:2048
    ds_read_b128 v[68:71], v14 offset:3072
    ds_read_b128 v[72:75], v14 offset:4096
    s_waitcnt lgkmcnt(14)
    v_mfma_f32_16x16x32_bf16 v[216:219], v[210:213], v[16:19], v[216:219]
    v_mov_b32 v195, 0xbdd2d3e8
    v_mfma_f32_16x16x32_bf16 v[220:223], v[208:211], v[16:19], v[220:223]
    ds_read_b128 a[108:111], v86 offset:0
    v_mov_b32 v196, 0xc0135761
    s_waitcnt lgkmcnt(14)
    v_mfma_f32_16x16x32_bf16 v[224:227], v[210:213], v[20:23], v[224:227]
    ds_read_b128 a[112:115], v86 offset:64
    buffer_load_dwordx4 a[48:51], v1, s[8:11], s37 offen offset:3072 sc1
    v_mfma_f32_16x16x32_bf16 v[228:231], v[208:211], v[20:23], v[228:231]
    ds_read_b128 a[116:119], v86 offset:128
    v_mov_b32 v172, 0
    v_mov_b32 v173, 0
    s_waitcnt lgkmcnt(15)
    v_mfma_f32_16x16x32_bf16 v[232:235], v[210:213], v[24:27], v[232:235]
    ds_read_b128 a[120:123], v86 offset:192
    v_mov_b32 v174, 0
    v_mfma_f32_16x16x32_bf16 v[236:239], v[208:211], v[24:27], v[236:239]
    ds_read_b128 a[124:127], v86 offset:256
    v_mov_b32 v175, 0
    s_waitcnt lgkmcnt(15)
    v_mfma_f32_16x16x32_bf16 v[240:243], v[210:213], v[28:31], v[240:243]
    buffer_load_dwordx4 a[52:55], v2, s[8:11], s37 offen offset:0 sc1
    v_mov_b32 v176, 0
    v_mfma_f32_16x16x32_bf16 v[244:247], v[208:211], v[28:31], v[244:247]
    ds_read_b128 a[128:131], v86 offset:5120
    v_mov_b32 v177, 0
    v_mfma_f32_16x16x32_bf16 v[248:251], v[210:213], v[32:35], v[248:251]
    ds_read_b128 a[132:135], v86 offset:5184
    v_mul_u32_u24 v88, 72, v9
    v_mfma_f32_16x16x32_bf16 v[252:255], v[208:211], v[32:35], v[252:255]
    ds_read_b128 a[136:139], v86 offset:5248
    v_lshl_add_u32 v88, v10, 3, v88
    buffer_load_dwordx4 a[56:59], v2, s[8:11], s37 offen offset:1024 sc1
    s_waitcnt lgkmcnt(15)
    v_mfma_f32_16x16x32_bf16 v[216:219], v[210:213], v[36:39], v[216:219]
    ds_read_b128 a[140:143], v86 offset:5312
    s_mul_i32 s3, s86, 1152
    v_mfma_f32_16x16x32_bf16 v[220:223], v[208:211], v[36:39], v[220:223]
    ds_read_b128 a[144:147], v86 offset:5376
    s_add_u32 s3, s3, 137856
    v_mfma_f32_16x16x32_bf16 v[224:227], v[210:213], v[40:43], v[224:227]
    v_add_u32 v89, s3, v88
    v_mfma_f32_16x16x32_bf16 v[228:231], v[208:211], v[40:43], v[228:231]
    ds_read_b128 a[148:151], v86 offset:10240
    v_mul_u32_u24 v90, 416, v10
    buffer_load_dwordx4 a[60:63], v2, s[8:11], s37 offen offset:2048 sc1
    v_mfma_f32_16x16x32_bf16 v[232:235], v[210:213], v[44:47], v[232:235]
    ds_read_b128 a[152:155], v86 offset:10304
    v_lshl_add_u32 v90, v9, 1, v90
    v_mfma_f32_16x16x32_bf16 v[236:239], v[208:211], v[44:47], v[236:239]
    ds_read_b128 a[156:159], v86 offset:10368
    s_mul_i32 s30, s85, 1664
    s_waitcnt lgkmcnt(15)
    v_mfma_f32_16x16x32_bf16 v[240:243], v[210:213], v[48:51], v[240:243]
    ds_read_b128 a[160:163], v86 offset:10432
    s_add_u32 s30, s30, 122880
    v_add_u32 v90, s30, v90
    v_mfma_f32_16x16x32_bf16 v[244:247], v[208:211], v[48:51], v[244:247]
    ds_read_b128 a[164:167], v86 offset:10496
    buffer_load_dwordx4 a[64:67], v2, s[8:11], s37 offen offset:3072 sc1
    v_mfma_f32_16x16x32_bf16 v[248:251], v[210:213], v[52:55], v[248:251]
    v_lshrrev_b32 v93, 2, v0
    v_mfma_f32_16x16x32_bf16 v[252:255], v[208:211], v[52:55], v[252:255]
    ds_read_b128 v[96:99], v87 offset:2560
    v_and_b32 v94, 3, v0
    v_lshlrev_b32 v94, 3, v94
    v_mfma_f32_16x16x32_bf16 v[216:219], v[210:213], v[56:59], v[216:219]
    ds_read_b128 v[100:103], v87 offset:2624
    v_mul_u32_u24 v91, 104, v93
    v_mfma_f32_16x16x32_bf16 v[220:223], v[208:211], v[56:59], v[220:223]
    ds_read_b128 v[104:107], v87 offset:2688
    buffer_load_dwordx4 a[68:71], v3, s[8:11], s37 offen offset:0 sc1
    v_mfma_f32_16x16x32_bf16 v[224:227], v[210:213], v[60:63], v[224:227]
    ds_read_b128 v[108:111], v87 offset:2752
    v_add_u32 v91, v91, v94
    v_mfma_f32_16x16x32_bf16 v[228:231], v[208:211], v[60:63], v[228:231]
    ds_read_b128 v[112:115], v87 offset:2816
    v_add_u32 v91, s30, v91
    v_mul_u32_u24 v92, 72, v93
    v_mfma_f32_16x16x32_bf16 v[232:235], v[210:213], v[64:67], v[232:235]
    v_add_u32 v92, v92, v94
    v_mfma_f32_16x16x32_bf16 v[236:239], v[208:211], v[64:67], v[236:239]
    ds_read_b128 v[116:119], v87 offset:7680
    s_mul_i32 s3, s85, 1152
    s_waitcnt lgkmcnt(15)
    v_mfma_f32_16x16x32_bf16 v[240:243], v[210:213], v[68:71], v[240:243]
    ds_read_b128 v[120:123], v87 offset:7744
    s_add_u32 s3, s3, 137856
    v_add_u32 v92, s3, v92
    v_mfma_f32_16x16x32_bf16 v[244:247], v[208:211], v[68:71], v[244:247]
    ds_read_b128 v[124:127], v87 offset:7808
    v_mul_u32_u24 v93, 40, v0
    v_mfma_f32_16x16x32_bf16 v[248:251], v[210:213], v[72:75], v[248:251]
    ds_read_b128 v[128:131], v87 offset:7872
    s_mul_i32 s31, s85, 2560
    v_mfma_f32_16x16x32_bf16 v[252:255], v[208:211], v[72:75], v[252:255]
    ds_read_b128 v[132:135], v87 offset:7936
    s_add_u32 s31, s31, 2785280
    v_add_u32 v95, s89, v1
    s_mul_i32 s3, s16, 252
    s_lshl_b32 s21, s18, 2
    s_add_u32 s3, s3, s21
    s_add_u32 s3, s3, s19
    s_lshl_b32 s34, s3, 1
    s_cmp_ge_u32 s73, 2
    s_cbranch_scc1 TL_NOSEND
    v_add_f32 v252, v252, v253
    v_cvt_pk_bf16_f32 v16, v216, v217
    v_cvt_pk_bf16_f32 v17, v218, v219
    v_cvt_pk_bf16_f32 v18, v220, v221
    v_cvt_pk_bf16_f32 v19, v222, v223
    v_cvt_pk_bf16_f32 v20, v224, v225
    v_cvt_pk_bf16_f32 v21, v226, v227
    v_cvt_pk_bf16_f32 v22, v228, v229
    v_cvt_pk_bf16_f32 v23, v230, v231
    v_cvt_pk_bf16_f32 v24, v232, v233
    v_cvt_pk_bf16_f32 v25, v234, v235
    v_cvt_pk_bf16_f32 v26, v236, v237
    v_cvt_pk_bf16_f32 v27, v238, v239
    v_cvt_pk_bf16_f32 v28, v240, v241
    v_cvt_pk_bf16_f32 v29, v242, v243
    v_cvt_pk_bf16_f32 v30, v244, v245
    v_cvt_pk_bf16_f32 v31, v246, v247
    v_cvt_pk_bf16_f32 v32, v248, v249
    v_cvt_pk_bf16_f32 v33, v250, v251
    v_and_b32 v34, 0xffff0000, v252
    v_sub_f32 v253, v252, v34
    v_cvt_pk_bf16_f32 v34, v34, v253
    v_mov_b32 v35, 0
    s_add_u32 s3, s34, s17
    s_mul_i32 s21, s3, 5120
    s_add_u32 s21, s21, 3145728
    buffer_store_dwordx4 v[16:19], v1, s[8:11], s21 offen offset:0 sc1
    buffer_store_dwordx4 v[20:23], v1, s[8:11], s21 offen offset:1024 sc1
    buffer_store_dwordx4 v[24:27], v1, s[8:11], s21 offen offset:2048 sc1
    buffer_store_dwordx4 v[28:31], v1, s[8:11], s21 offen offset:3072 sc1
    buffer_store_dwordx4 v[32:35], v2, s[8:11], s21 offen sc1
TL_NOSEND:
    s_cmp_lt_u32 s23, 125
    s_cbranch_scc1 TL_ALIVE
    s_cmp_ge_u32 s73, 2
    s_cbranch_scc1 K_END
    s_add_u32 s3, s34, s17
    s_lshl_b32 s3, s3, 6
    s_add_u32 s3, s3, 8454144
    v_mov_b32 v13, s3
    v_mov_b32 v14, s64
    s_mov_b64 exec, 1
    s_waitcnt vmcnt(0)
    buffer_store_dword v14, v13, s[8:11], 0 offen sc1
    s_mov_b64 exec, -1
TL_DEADS:
    s_endpgm
TL_ALIVE:
    s_waitcnt vmcnt(42)
    v_mfma_f32_16x16x32_bf16 v[16:19], a[188:191], a[108:111], 0
    s_waitcnt vmcnt(41)
    v_mfma_f32_16x16x32_bf16 v[16:19], a[192:195], a[112:115], v[16:19]
    s_waitcnt vmcnt(40)
    v_mfma_f32_16x16x32_bf16 v[16:19], a[196:199], a[116:119], v[16:19]
    s_waitcnt vmcnt(39)
    v_mfma_f32_16x16x32_bf16 v[16:19], a[200:203], a[120:123], v[16:19]
    s_waitcnt vmcnt(38)
    v_mfma_f32_16x16x32_bf16 v[16:19], a[204:207], a[124:127], v[16:19]
    v_mfma_f32_16x16x32_bf16 v[20:23], a[188:191], a[128:131], 0
    s_waitcnt lgkmcnt(15)
    v_mfma_f32_16x16x32_bf16 v[20:23], a[192:195], a[132:135], v[20:23]
    v_mfma_f32_16x16x32_bf16 v[20:23], a[196:199], a[136:139], v[20:23]
    v_mfma_f32_16x16x32_bf16 v[20:23], a[200:203], a[140:143], v[20:23]
    v_mfma_f32_16x16x32_bf16 v[20:23], a[204:207], a[144:147], v[20:23]
    s_waitcnt lgkmcnt(14)
    v_mfma_f32_16x16x32_bf16 v[24:27], a[188:191], a[148:151], 0
    s_waitcnt lgkmcnt(13)
    v_mfma_f32_16x16x32_bf16 v[24:27], a[192:195], a[152:155], v[24:27]
    s_waitcnt lgkmcnt(12)
    v_mfma_f32_16x16x32_bf16 v[24:27], a[196:199], a[156:159], v[24:27]
    s_waitcnt lgkmcnt(11)
    v_mfma_f32_16x16x32_bf16 v[24:27], a[200:203], a[160:163], v[24:27]
    s_waitcnt lgkmcnt(10)
    v_mfma_f32_16x16x32_bf16 v[24:27], a[204:207], a[164:167], v[24:27]
    s_waitcnt vmcnt(23)
    ds_read_b128 a[188:191], v95 offset:0
    ds_read_b128 a[192:195], v95 offset:1024
    ds_read_b128 a[196:199], v95 offset:2048
    ds_read_b128 a[200:203], v95 offset:3072
    ds_read_b128 a[204:207], v95 offset:4096
    v_mul_f32 v160, v16, v16
    v_fma_f32 v160, v160, v195, v196
    v_mul_f32 v160, v160, v16
    v_mfma_f32_16x16x32_bf16 v[28:31], a[208:211], a[108:111], 0
    v_exp_f32 v160, v160
    v_mul_f32 v161, v17, v17
    v_fma_f32 v161, v161, v195, v196
    v_mul_f32 v161, v161, v17
    v_exp_f32 v161, v161
    v_mul_f32 v162, v18, v18
    v_mfma_f32_16x16x32_bf16 v[28:31], a[212:215], a[112:115], v[28:31]
    v_fma_f32 v162, v162, v195, v196
    v_mul_f32 v162, v162, v18
    v_exp_f32 v162, v162
    v_mul_f32 v163, v19, v19
    v_fma_f32 v163, v163, v195, v196
    v_mul_f32 v163, v163, v19
    v_exp_f32 v163, v163
    v_mfma_f32_16x16x32_bf16 v[28:31], a[216:219], a[116:119], v[28:31]
    v_add_f32 v160, 1.0, v160
    v_add_f32 v161, 1.0, v161
    v_rcp_f32 v160, v160
    v_add_f32 v162, 1.0, v162
    v_add_f32 v163, 1.0, v163
    v_rcp_f32 v161, v161
    v_mul_f32 v164, v20, v20
    v_mfma_f32_16x16x32_bf16 v[28:31], a[220:223], a[120:123], v[28:31]
    v_fma_f32 v164, v164, v195, v196
    v_rcp_f32 v162, v162
    v_mul_f32 v164, v164, v20
    v_mul_f32 v165, v21, v21
    v_rcp_f32 v163, v163
    v_fma_f32 v165, v165, v195, v196
    v_mul_f32 v165, v165, v21
    v_mfma_f32_16x16x32_bf16 v[28:31], a[224:227], a[124:127], v[28:31]
    v_exp_f32 v164, v164
    v_mul_f32 v166, v22, v22
    v_fma_f32 v166, v166, v195, v196
    v_exp_f32 v165, v165
    v_mul_f32 v166, v166, v22
    v_mul_f32 v167, v23, v23
    v_mfma_f32_16x16x32_bf16 v[32:35], a[208:211], a[128:131], 0
    v_exp_f32 v166, v166
    v_fma_f32 v167, v167, v195, v196
    v_mul_f32 v167, v167, v23
    v_exp_f32 v167, v167
    v_add_f32 v164, 1.0, v164
    v_add_f32 v165, 1.0, v165
    v_rcp_f32 v164, v164
    v_mfma_f32_16x16x32_bf16 v[32:35], a[212:215], a[132:135], v[32:35]
    v_add_f32 v166, 1.0, v166
    v_add_f32 v167, 1.0, v167
    v_rcp_f32 v165, v165
    v_mul_f32 v168, v24, v24
    v_fma_f32 v168, v168, v195, v196
    v_rcp_f32 v166, v166
    v_mul_f32 v168, v168, v24
    v_mfma_f32_16x16x32_bf16 v[32:35], a[216:219], a[136:139], v[32:35]
    v_mul_f32 v169, v25, v25
    v_rcp_f32 v167, v167
    v_fma_f32 v169, v169, v195, v196
    v_mul_f32 v169, v169, v25
    v_exp_f32 v168, v168
    v_mul_f32 v170, v26, v26
    v_fma_f32 v170, v170, v195, v196
    v_mfma_f32_16x16x32_bf16 v[32:35], a[220:223], a[140:143], v[32:35]
    v_exp_f32 v169, v169
    v_mul_f32 v170, v170, v26
    v_mul_f32 v171, v27, v27
    v_exp_f32 v170, v170
    v_fma_f32 v171, v171, v195, v196
    v_mul_f32 v171, v171, v27
    v_mfma_f32_16x16x32_bf16 v[32:35], a[224:227], a[144:147], v[32:35]
    v_exp_f32 v171, v171
    v_add_f32 v168, 1.0, v168
    v_add_f32 v169, 1.0, v169
    v_rcp_f32 v168, v168
    v_add_f32 v170, 1.0, v170
    v_add_f32 v171, 1.0, v171
    v_rcp_f32 v169, v169
    v_mfma_f32_16x16x32_bf16 v[36:39], a[208:211], a[148:151], 0
    v_mul_f32 v16, v16, v160
    v_mul_f32 v17, v17, v161
    v_rcp_f32 v170, v170
    v_mul_f32 v18, v18, v162
    v_mul_f32 v19, v19, v163
    v_rcp_f32 v171, v171
    v_add_f32 v160, v16, v17
    v_mfma_f32_16x16x32_bf16 v[36:39], a[212:215], a[152:155], v[36:39]
    v_add_f32 v161, v18, v19
    v_fmac_f32 v173, v16, v16
    v_add_f32 v172, v172, v160
    v_fmac_f32 v173, v17, v17
    v_add_f32 v172, v172, v161
    v_fmac_f32 v173, v18, v18
    v_fmac_f32 v173, v19, v19
    v_mfma_f32_16x16x32_bf16 v[36:39], a[216:219], a[156:159], v[36:39]
    v_mul_f32 v20, v20, v164
    v_mul_f32 v21, v21, v165
    v_mul_f32 v22, v22, v166
    v_mul_f32 v23, v23, v167
    v_add_f32 v164, v20, v21
    v_add_f32 v165, v22, v23
    v_mfma_f32_16x16x32_bf16 v[36:39], a[220:223], a[160:163], v[36:39]
    v_fmac_f32 v175, v20, v20
    v_add_f32 v174, v174, v164
    v_fmac_f32 v175, v21, v21
    v_add_f32 v174, v174, v165
    v_fmac_f32 v175, v22, v22
    v_fmac_f32 v175, v23, v23
    v_mul_f32 v24, v24, v168
    v_mfma_f32_16x16x32_bf16 v[36:39], a[224:227], a[164:167], v[36:39]
    v_mul_f32 v25, v25, v169
    v_mul_f32 v26, v26, v170
    v_mul_f32 v27, v27, v171
    v_add_f32 v168, v24, v25
    v_add_f32 v169, v26, v27
    v_fmac_f32 v177, v24, v24
    v_add_f32 v176, v176, v168
    v_fmac_f32 v177, v25, v25
    v_add_f32 v176, v176, v169
    v_fmac_f32 v177, v26, v26
    v_fmac_f32 v177, v27, v27
    s_cmp_lg_u32 s73, 0
    s_cbranch_scc1 TL_R1
    v_mul_f32 v160, v28, v28
    v_fma_f32 v160, v160, v195, v196
    v_mul_f32 v160, v160, v28
    v_mfma_f32_16x16x32_bf16 v[40:43], a[228:231], a[108:111], 0
    v_exp_f32 v160, v160
    v_mul_f32 v161, v29, v29
    v_fma_f32 v161, v161, v195, v196
    v_mul_f32 v161, v161, v29
    v_exp_f32 v161, v161
    s_mov_b32 s38, 2891776
    v_mul_f32 v162, v30, v30
    v_mfma_f32_16x16x32_bf16 v[40:43], a[232:235], a[112:115], v[40:43]
    v_fma_f32 v162, v162, v195, v196
    v_mul_f32 v162, v162, v30
    v_exp_f32 v162, v162
    v_mul_f32 v163, v31, v31
    v_fma_f32 v163, v163, v195, v196
    v_mul_f32 v163, v163, v31
    v_exp_f32 v163, v163
    v_mfma_f32_16x16x32_bf16 v[40:43], a[236:239], a[116:119], v[40:43]
    v_add_f32 v160, 1.0, v160
    v_add_f32 v161, 1.0, v161
    v_rcp_f32 v160, v160
    v_add_f32 v162, 1.0, v162
    v_add_f32 v163, 1.0, v163
    v_rcp_f32 v161, v161
    v_mul_f32 v164, v32, v32
    v_mfma_f32_16x16x32_bf16 v[40:43], a[240:243], a[120:123], v[40:43]
    v_fma_f32 v164, v164, v195, v196
    buffer_load_dwordx4 a[72:75], v1, s[8:11], s38 offen offset:0 sc1
    v_rcp_f32 v162, v162
    v_mul_f32 v164, v164, v32
    v_mul_f32 v165, v33, v33
    v_rcp_f32 v163, v163
    v_fma_f32 v165, v165, v195, v196
    v_mul_f32 v165, v165, v33
    v_mfma_f32_16x16x32_bf16 v[40:43], a[244:247], a[124:127], v[40:43]
    v_exp_f32 v164, v164
    v_mul_f32 v166, v34, v34
    v_fma_f32 v166, v166, v195, v196
    v_exp_f32 v165, v165
    v_mul_f32 v166, v166, v34
    v_mul_f32 v167, v35, v35
    v_mfma_f32_16x16x32_bf16 v[44:47], a[228:231], a[128:131], 0
    v_exp_f32 v166, v166
    v_fma_f32 v167, v167, v195, v196
    v_mul_f32 v167, v167, v35
    buffer_load_dwordx4 a[76:79], v1, s[8:11], s38 offen offset:1024 sc1
    v_exp_f32 v167, v167
    v_add_f32 v164, 1.0, v164
    v_add_f32 v165, 1.0, v165
    v_rcp_f32 v164, v164
    v_mfma_f32_16x16x32_bf16 v[44:47], a[232:235], a[132:135], v[44:47]
    v_add_f32 v166, 1.0, v166
    v_add_f32 v167, 1.0, v167
    v_rcp_f32 v165, v165
    v_mul_f32 v168, v36, v36
    v_fma_f32 v168, v168, v195, v196
    v_rcp_f32 v166, v166
    v_mul_f32 v168, v168, v36
    v_mfma_f32_16x16x32_bf16 v[44:47], a[236:239], a[136:139], v[44:47]
    v_mul_f32 v169, v37, v37
    v_rcp_f32 v167, v167
    v_fma_f32 v169, v169, v195, v196
    v_mul_f32 v169, v169, v37
    buffer_load_dwordx4 a[80:83], v1, s[8:11], s38 offen offset:2048 sc1
    v_exp_f32 v168, v168
    v_mul_f32 v170, v38, v38
    v_fma_f32 v170, v170, v195, v196
    v_mfma_f32_16x16x32_bf16 v[44:47], a[240:243], a[140:143], v[44:47]
    v_exp_f32 v169, v169
    v_mul_f32 v170, v170, v38
    v_mul_f32 v171, v39, v39
    v_exp_f32 v170, v170
    v_fma_f32 v171, v171, v195, v196
    v_mul_f32 v171, v171, v39
    v_mfma_f32_16x16x32_bf16 v[44:47], a[244:247], a[144:147], v[44:47]
    v_exp_f32 v171, v171
    v_add_f32 v168, 1.0, v168
    v_add_f32 v169, 1.0, v169
    v_rcp_f32 v168, v168
    v_add_f32 v170, 1.0, v170
    v_add_f32 v171, 1.0, v171
    v_rcp_f32 v169, v169
    v_mfma_f32_16x16x32_bf16 v[48:51], a[228:231], a[148:151], 0
    buffer_load_dwordx4 a[84:87], v1, s[8:11], s38 offen offset:3072 sc1
    v_mul_f32 v28, v28, v160
    v_mul_f32 v29, v29, v161
    v_rcp_f32 v170, v170
    v_mul_f32 v30, v30, v162
    v_mul_f32 v31, v31, v163
    v_rcp_f32 v171, v171
    v_add_f32 v160, v28, v29
    v_mfma_f32_16x16x32_bf16 v[48:51], a[232:235], a[152:155], v[48:51]
    v_add_f32 v161, v30, v31
    v_fmac_f32 v173, v28, v28
    v_add_f32 v172, v172, v160
    v_fmac_f32 v173, v29, v29
    v_add_f32 v172, v172, v161
    v_fmac_f32 v173, v30, v30
    v_fmac_f32 v173, v31, v31
    v_mfma_f32_16x16x32_bf16 v[48:51], a[236:239], a[156:159], v[48:51]
    v_mul_f32 v32, v32, v164
    buffer_load_dwordx4 a[88:91], v2, s[8:11], s38 offen offset:0 sc1
    v_mul_f32 v33, v33, v165
    v_mul_f32 v34, v34, v166
    v_mul_f32 v35, v35, v167
    v_add_f32 v164, v32, v33
    v_add_f32 v165, v34, v35
    v_mfma_f32_16x16x32_bf16 v[48:51], a[240:243], a[160:163], v[48:51]
    v_fmac_f32 v175, v32, v32
    v_add_f32 v174, v174, v164
    v_fmac_f32 v175, v33, v33
    v_add_f32 v174, v174, v165
    v_fmac_f32 v175, v34, v34
    v_fmac_f32 v175, v35, v35
    v_mul_f32 v36, v36, v168
    v_mfma_f32_16x16x32_bf16 v[48:51], a[244:247], a[164:167], v[48:51]
    v_mul_f32 v37, v37, v169
    v_mul_f32 v38, v38, v170
    v_mul_f32 v39, v39, v171
    v_add_f32 v168, v36, v37
    v_add_f32 v169, v38, v39
    v_fmac_f32 v177, v36, v36
    v_add_f32 v176, v176, v168
    v_fmac_f32 v177, v37, v37
    v_add_f32 v176, v176, v169
    v_fmac_f32 v177, v38, v38
    v_fmac_f32 v177, v39, v39
    s_add_u32 s3, s34, s17
    s_lshl_b32 s3, s3, 6
    s_add_u32 s3, s3, 8454144
    v_mov_b32 v13, s3
    v_mov_b32 v14, s64
    s_mov_b64 exec, 1
    s_waitcnt vmcnt(5)
    buffer_store_dword v14, v13, s[8:11], 0 offen sc1
    s_mov_b64 exec, -1
    v_mul_f32 v160, v40, v40
    v_fma_f32 v160, v160, v195, v196
    v_mul_f32 v160, v160, v40
    s_waitcnt lgkmcnt(4)
    v_mfma_f32_16x16x32_bf16 v[136:139], v[96:99], a[188:191], 0
    v_exp_f32 v160, v160
    buffer_load_dwordx4 a[92:95], v2, s[8:11], s38 offen offset:1024 sc1
    v_mul_f32 v161, v41, v41
    v_fma_f32 v161, v161, v195, v196
    v_mul_f32 v161, v161, v41
    v_exp_f32 v161, v161
    v_mul_f32 v162, v42, v42
    v_fma_f32 v162, v162, v195, v196
    buffer_load_dwordx4 a[96:99], v2, s[8:11], s38 offen offset:2048 sc1
    v_mul_f32 v162, v162, v42
    v_exp_f32 v162, v162
    v_mul_f32 v163, v43, v43
    s_waitcnt lgkmcnt(3)
    v_mfma_f32_16x16x32_bf16 v[136:139], v[100:103], a[192:195], v[136:139]
    v_fma_f32 v163, v163, v195, v196
    v_mul_f32 v163, v163, v43
    v_exp_f32 v163, v163
    buffer_load_dwordx4 a[100:103], v2, s[8:11], s38 offen offset:3072 sc1
    v_add_f32 v160, 1.0, v160
    v_add_f32 v161, 1.0, v161
    v_rcp_f32 v160, v160
    v_add_f32 v162, 1.0, v162
    v_add_f32 v163, 1.0, v163
    v_rcp_f32 v161, v161
    v_mul_f32 v164, v44, v44
    s_waitcnt lgkmcnt(2)
    v_mfma_f32_16x16x32_bf16 v[136:139], v[104:107], a[196:199], v[136:139]
    buffer_load_dwordx4 a[104:107], v3, s[8:11], s38 offen offset:0 sc1
    v_fma_f32 v164, v164, v195, v196
    v_rcp_f32 v162, v162
    v_mul_f32 v164, v164, v44
    v_mul_f32 v165, v45, v45
    v_rcp_f32 v163, v163
    v_fma_f32 v165, v165, v195, v196
    s_add_u32 s33, s31, 0
    v_mul_f32 v165, v165, v45
    v_exp_f32 v164, v164
    v_mul_f32 v166, v46, v46
    v_fma_f32 v166, v166, v195, v196
    s_waitcnt lgkmcnt(1)
    v_mfma_f32_16x16x32_bf16 v[136:139], v[108:111], a[200:203], v[136:139]
    v_exp_f32 v165, v165
    v_mul_f32 v166, v166, v46
    buffer_load_dwordx4 a[128:131], v93, s[8:11], s33 offen sc1
    v_mul_f32 v167, v47, v47
    v_exp_f32 v166, v166
    v_fma_f32 v167, v167, v195, v196
    v_mul_f32 v167, v167, v47
    v_exp_f32 v167, v167
    v_add_f32 v164, 1.0, v164
    v_add_f32 v165, 1.0, v165
    buffer_load_dwordx4 a[132:135], v93, s[8:11], s33 offen offset:16 sc1
    v_rcp_f32 v164, v164
    s_waitcnt lgkmcnt(0)
    v_mfma_f32_16x16x32_bf16 v[136:139], v[112:115], a[204:207], v[136:139]
    v_add_f32 v166, 1.0, v166
    v_add_f32 v167, 1.0, v167
    v_rcp_f32 v165, v165
    v_mul_f32 v168, v48, v48
    v_fma_f32 v168, v168, v195, v196
    buffer_load_dwordx2 a[136:137], v93, s[8:11], s33 offen offset:32 sc1
    v_rcp_f32 v166, v166
    v_mul_f32 v168, v168, v48
    v_mul_f32 v169, v49, v49
    v_rcp_f32 v167, v167
    v_fma_f32 v169, v169, v195, v196
    v_mfma_f32_16x16x32_bf16 v[140:143], v[116:119], a[188:191], 0
    v_mul_f32 v169, v169, v49
    s_add_u32 s33, s31, 2560
    v_exp_f32 v168, v168
    v_mul_f32 v170, v50, v50
    v_fma_f32 v170, v170, v195, v196
    v_exp_f32 v169, v169
    v_mul_f32 v170, v170, v50
    v_mul_f32 v171, v51, v51
    v_exp_f32 v170, v170
    buffer_load_dwordx4 a[138:141], v93, s[8:11], s33 offen sc1
    v_fma_f32 v171, v171, v195, v196
    v_mfma_f32_16x16x32_bf16 v[140:143], v[120:123], a[192:195], v[140:143]
    v_mul_f32 v171, v171, v51
    v_exp_f32 v171, v171
    v_add_f32 v168, 1.0, v168
    v_add_f32 v169, 1.0, v169
    v_rcp_f32 v168, v168
    buffer_load_dwordx4 a[142:145], v93, s[8:11], s33 offen offset:16 sc1
    v_add_f32 v170, 1.0, v170
    v_add_f32 v171, 1.0, v171
    v_rcp_f32 v169, v169
    v_mul_f32 v40, v40, v160
    v_mul_f32 v41, v41, v161
    v_mfma_f32_16x16x32_bf16 v[140:143], v[124:127], a[196:199], v[140:143]
    v_rcp_f32 v170, v170
    v_mul_f32 v42, v42, v162
    buffer_load_dwordx2 a[146:147], v93, s[8:11], s33 offen offset:32 sc1
    v_mul_f32 v43, v43, v163
    v_rcp_f32 v171, v171
    v_add_f32 v160, v40, v41
    v_add_f32 v161, v42, v43
    v_fmac_f32 v173, v40, v40
    v_add_f32 v172, v172, v160
    s_add_u32 s33, s31, 5120
    v_fmac_f32 v173, v41, v41
    v_add_f32 v172, v172, v161
    v_mfma_f32_16x16x32_bf16 v[140:143], v[128:131], a[200:203], v[140:143]
    v_fmac_f32 v173, v42, v42
    v_fmac_f32 v173, v43, v43
    v_mul_f32 v44, v44, v164
    v_mul_f32 v45, v45, v165
    buffer_load_dwordx4 a[148:151], v93, s[8:11], s33 offen sc1
    v_mul_f32 v46, v46, v166
    v_mul_f32 v47, v47, v167
    v_add_f32 v164, v44, v45
    v_add_f32 v165, v46, v47
    v_fmac_f32 v175, v44, v44
    v_add_f32 v174, v174, v164
    v_mfma_f32_16x16x32_bf16 v[140:143], v[132:135], a[204:207], v[140:143]
    v_fmac_f32 v175, v45, v45
    buffer_load_dwordx4 a[152:155], v93, s[8:11], s33 offen offset:16 sc1
    v_add_f32 v174, v174, v165
    v_fmac_f32 v175, v46, v46
    v_fmac_f32 v175, v47, v47
    v_mul_f32 v48, v48, v168
    v_mul_f32 v49, v49, v169
    v_mul_f32 v50, v50, v170
    buffer_load_dwordx2 a[156:157], v93, s[8:11], s33 offen offset:32 sc1
    v_mul_f32 v51, v51, v171
    v_add_f32 v168, v48, v49
    v_add_f32 v169, v50, v51
    v_fmac_f32 v177, v48, v48
    v_add_f32 v176, v176, v168
    v_fmac_f32 v177, v49, v49
    v_add_f32 v176, v176, v169
    v_fmac_f32 v177, v50, v50
    v_fmac_f32 v177, v51, v51
    s_branch TL_RJ
TL_R1:
    s_cmp_eq_u32 s73, 3
    s_cbranch_scc1 TL_R3
    s_waitcnt vmcnt(18)
    ds_read_b128 a[208:211], v95 offset:40960
    ds_read_b128 a[212:215], v95 offset:41984
    ds_read_b128 a[216:219], v95 offset:43008
    ds_read_b128 a[220:223], v95 offset:44032
    ds_read_b128 a[224:227], v95 offset:45056
    v_mul_f32 v160, v28, v28
    v_fma_f32 v160, v160, v195, v196
    v_mul_f32 v160, v160, v28
    s_waitcnt lgkmcnt(15)
    v_mfma_f32_16x16x32_bf16 v[136:139], v[96:99], a[228:231], 0
    v_exp_f32 v160, v160
    v_mul_f32 v161, v29, v29
    v_fma_f32 v161, v161, v195, v196
    s_add_u32 s33, s31, 0
    v_mul_f32 v161, v161, v29
    v_exp_f32 v161, v161
    v_mul_f32 v162, v30, v30
    v_fma_f32 v162, v162, v195, v196
    v_mul_f32 v162, v162, v30
    v_exp_f32 v162, v162
    v_mul_f32 v163, v31, v31
    v_mfma_f32_16x16x32_bf16 v[136:139], v[100:103], a[232:235], v[136:139]
    v_fma_f32 v163, v163, v195, v196
    v_mul_f32 v163, v163, v31
    v_exp_f32 v163, v163
    v_add_f32 v160, 1.0, v160
    v_add_f32 v161, 1.0, v161
    buffer_load_dwordx4 a[128:131], v93, s[8:11], s33 offen sc1
    v_rcp_f32 v160, v160
    v_add_f32 v162, 1.0, v162
    v_add_f32 v163, 1.0, v163
    v_rcp_f32 v161, v161
    v_mul_f32 v164, v32, v32
    v_mfma_f32_16x16x32_bf16 v[136:139], v[104:107], a[236:239], v[136:139]
    v_fma_f32 v164, v164, v195, v196
    v_rcp_f32 v162, v162
    v_mul_f32 v164, v164, v32
    v_mul_f32 v165, v33, v33
    v_rcp_f32 v163, v163
    v_fma_f32 v165, v165, v195, v196
    v_mul_f32 v165, v165, v33
    buffer_load_dwordx4 a[132:135], v93, s[8:11], s33 offen offset:16 sc1
    v_exp_f32 v164, v164
    v_mul_f32 v166, v34, v34
    v_fma_f32 v166, v166, v195, v196
    v_mfma_f32_16x16x32_bf16 v[136:139], v[108:111], a[240:243], v[136:139]
    v_exp_f32 v165, v165
    v_mul_f32 v166, v166, v34
    v_mul_f32 v167, v35, v35
    v_exp_f32 v166, v166
    v_fma_f32 v167, v167, v195, v196
    v_mul_f32 v167, v167, v35
    v_exp_f32 v167, v167
    v_add_f32 v164, 1.0, v164
    v_add_f32 v165, 1.0, v165
    buffer_load_dwordx2 a[136:137], v93, s[8:11], s33 offen offset:32 sc1
    v_rcp_f32 v164, v164
    v_mfma_f32_16x16x32_bf16 v[136:139], v[112:115], a[244:247], v[136:139]
    v_add_f32 v166, 1.0, v166
    v_add_f32 v167, 1.0, v167
    v_rcp_f32 v165, v165
    v_mul_f32 v168, v36, v36
    v_fma_f32 v168, v168, v195, v196
    v_rcp_f32 v166, v166
    v_mul_f32 v168, v168, v36
    v_mul_f32 v169, v37, v37
    v_rcp_f32 v167, v167
    v_fma_f32 v169, v169, v195, v196
    s_waitcnt lgkmcnt(14)
    v_mfma_f32_16x16x32_bf16 v[140:143], v[116:119], a[228:231], 0
    v_mul_f32 v169, v169, v37
    s_add_u32 s33, s31, 2560
    v_exp_f32 v168, v168
    v_mul_f32 v170, v38, v38
    v_fma_f32 v170, v170, v195, v196
    v_exp_f32 v169, v169
    v_mul_f32 v170, v170, v38
    v_mul_f32 v171, v39, v39
    v_exp_f32 v170, v170
    v_fma_f32 v171, v171, v195, v196
    s_waitcnt lgkmcnt(13)
    v_mfma_f32_16x16x32_bf16 v[140:143], v[120:123], a[232:235], v[140:143]
    v_mul_f32 v171, v171, v39
    v_exp_f32 v171, v171
    v_add_f32 v168, 1.0, v168
    v_add_f32 v169, 1.0, v169
    buffer_load_dwordx4 a[138:141], v93, s[8:11], s33 offen sc1
    v_rcp_f32 v168, v168
    v_add_f32 v170, 1.0, v170
    v_add_f32 v171, 1.0, v171
    v_rcp_f32 v169, v169
    v_mul_f32 v28, v28, v160
    v_mul_f32 v29, v29, v161
    s_waitcnt lgkmcnt(12)
    v_mfma_f32_16x16x32_bf16 v[140:143], v[124:127], a[236:239], v[140:143]
    v_rcp_f32 v170, v170
    v_mul_f32 v30, v30, v162
    v_mul_f32 v31, v31, v163
    v_rcp_f32 v171, v171
    v_add_f32 v160, v28, v29
    v_add_f32 v161, v30, v31
    buffer_load_dwordx4 a[142:145], v93, s[8:11], s33 offen offset:16 sc1
    v_fmac_f32 v173, v28, v28
    v_add_f32 v172, v172, v160
    v_fmac_f32 v173, v29, v29
    v_add_f32 v172, v172, v161
    s_waitcnt lgkmcnt(11)
    v_mfma_f32_16x16x32_bf16 v[140:143], v[128:131], a[240:243], v[140:143]
    v_fmac_f32 v173, v30, v30
    v_fmac_f32 v173, v31, v31
    v_mul_f32 v32, v32, v164
    v_mul_f32 v33, v33, v165
    v_mul_f32 v34, v34, v166
    v_mul_f32 v35, v35, v167
    v_add_f32 v164, v32, v33
    v_add_f32 v165, v34, v35
    buffer_load_dwordx2 a[146:147], v93, s[8:11], s33 offen offset:32 sc1
    v_fmac_f32 v175, v32, v32
    v_add_f32 v174, v174, v164
    s_waitcnt lgkmcnt(10)
    v_mfma_f32_16x16x32_bf16 v[140:143], v[132:135], a[244:247], v[140:143]
    v_fmac_f32 v175, v33, v33
    v_add_f32 v174, v174, v165
    v_fmac_f32 v175, v34, v34
    v_fmac_f32 v175, v35, v35
    v_mul_f32 v36, v36, v168
    v_mul_f32 v37, v37, v169
    v_mul_f32 v38, v38, v170
    v_mul_f32 v39, v39, v171
    v_add_f32 v168, v36, v37
    v_add_f32 v169, v38, v39
    v_fmac_f32 v177, v36, v36
    v_add_f32 v176, v176, v168
    v_fmac_f32 v177, v37, v37
    v_add_f32 v176, v176, v169
    v_fmac_f32 v177, v38, v38
    v_fmac_f32 v177, v39, v39
    s_cmp_ge_u32 s73, 2
    s_cbranch_scc1 TL_NOFLAG
    s_add_u32 s3, s34, s17
    s_lshl_b32 s3, s3, 6
    s_add_u32 s3, s3, 8454144
    v_mov_b32 v13, s3
    v_mov_b32 v14, s64
    s_mov_b64 exec, 1
    s_waitcnt vmcnt(6)
    buffer_store_dword v14, v13, s[8:11], 0 offen sc1
    s_mov_b64 exec, -1
TL_NOFLAG:
    v_mul_f32 v160, v136, v136
    v_fma_f32 v160, v160, v195, v196
    s_waitcnt lgkmcnt(9)
    v_mfma_f32_16x16x32_bf16 v[144:147], v[96:99], a[188:191], 0
    v_mul_f32 v160, v160, v136
    v_exp_f32 v160, v160
    v_mul_f32 v161, v137, v137
    v_fma_f32 v161, v161, v195, v196
    v_mul_f32 v161, v161, v137
    v_exp_f32 v161, v161
    s_waitcnt lgkmcnt(8)
    v_mfma_f32_16x16x32_bf16 v[144:147], v[100:103], a[192:195], v[144:147]
    v_mul_f32 v162, v138, v138
    v_fma_f32 v162, v162, v195, v196
    v_mul_f32 v162, v162, v138
    v_exp_f32 v162, v162
    v_mul_f32 v163, v139, v139
    v_fma_f32 v163, v163, v195, v196
    s_waitcnt lgkmcnt(7)
    v_mfma_f32_16x16x32_bf16 v[144:147], v[104:107], a[196:199], v[144:147]
    v_mul_f32 v163, v163, v139
    v_exp_f32 v163, v163
    v_add_f32 v160, 1.0, v160
    v_add_f32 v161, 1.0, v161
    v_rcp_f32 v160, v160
    s_waitcnt lgkmcnt(6)
    v_mfma_f32_16x16x32_bf16 v[144:147], v[108:111], a[200:203], v[144:147]
    v_add_f32 v162, 1.0, v162
    v_add_f32 v163, 1.0, v163
    v_rcp_f32 v161, v161
    v_mul_f32 v164, v140, v140
    v_fma_f32 v164, v164, v195, v196
    v_rcp_f32 v162, v162
    s_waitcnt lgkmcnt(5)
    v_mfma_f32_16x16x32_bf16 v[144:147], v[112:115], a[204:207], v[144:147]
    v_mul_f32 v164, v164, v140
    v_mul_f32 v165, v141, v141
    v_rcp_f32 v163, v163
    v_fma_f32 v165, v165, v195, v196
    v_mul_f32 v165, v165, v141
    v_exp_f32 v164, v164
    v_mfma_f32_16x16x32_bf16 v[148:151], v[116:119], a[188:191], 0
    v_mul_f32 v166, v142, v142
    v_fma_f32 v166, v166, v195, v196
    v_exp_f32 v165, v165
    v_mul_f32 v166, v166, v142
    v_mul_f32 v167, v143, v143
    v_exp_f32 v166, v166
    v_mfma_f32_16x16x32_bf16 v[148:151], v[120:123], a[192:195], v[148:151]
    v_fma_f32 v167, v167, v195, v196
    v_mul_f32 v167, v167, v143
    v_exp_f32 v167, v167
    v_add_f32 v164, 1.0, v164
    v_add_f32 v165, 1.0, v165
    v_mfma_f32_16x16x32_bf16 v[148:151], v[124:127], a[196:199], v[148:151]
    v_rcp_f32 v164, v164
    v_add_f32 v166, 1.0, v166
    v_add_f32 v167, 1.0, v167
    v_rcp_f32 v165, v165
    v_mul_f32 v136, v136, v160
    v_mul_f32 v137, v137, v161
    v_mfma_f32_16x16x32_bf16 v[148:151], v[128:131], a[200:203], v[148:151]
    v_rcp_f32 v166, v166
    v_mul_f32 v138, v138, v162
    v_mul_f32 v139, v139, v163
    v_rcp_f32 v167, v167
    v_cvt_pk_bf16_f32 v162, v136, v137
    v_cvt_pk_bf16_f32 v163, v138, v139
    v_mfma_f32_16x16x32_bf16 v[148:151], v[132:135], a[204:207], v[148:151]
    ds_write_b64 v89, v[162:163] offset:0
    v_mul_f32 v140, v140, v164
    v_mul_f32 v141, v141, v165
    v_mul_f32 v142, v142, v166
    v_mul_f32 v143, v143, v167
    v_cvt_pk_bf16_f32 v166, v140, v141
    v_cvt_pk_bf16_f32 v167, v142, v143
    ds_write_b64 v89, v[166:167] offset:32
    v_add_u32 v89, 1152, v89
    v_mul_f32 v160, v144, v144
    v_fma_f32 v160, v160, v195, v196
    s_waitcnt lgkmcnt(6)
    v_mfma_f32_16x16x32_bf16 v[136:139], v[96:99], a[208:211], 0
    v_mul_f32 v160, v160, v144
    v_exp_f32 v160, v160
    v_mul_f32 v161, v145, v145
    v_fma_f32 v161, v161, v195, v196
    v_mul_f32 v161, v161, v145
    v_exp_f32 v161, v161
    s_waitcnt lgkmcnt(5)
    v_mfma_f32_16x16x32_bf16 v[136:139], v[100:103], a[212:215], v[136:139]
    v_mul_f32 v162, v146, v146
    v_fma_f32 v162, v162, v195, v196
    v_mul_f32 v162, v162, v146
    v_exp_f32 v162, v162
    v_mul_f32 v163, v147, v147
    v_fma_f32 v163, v163, v195, v196
    s_waitcnt lgkmcnt(4)
    v_mfma_f32_16x16x32_bf16 v[136:139], v[104:107], a[216:219], v[136:139]
    v_mul_f32 v163, v163, v147
    v_exp_f32 v163, v163
    v_add_f32 v160, 1.0, v160
    v_add_f32 v161, 1.0, v161
    v_rcp_f32 v160, v160
    s_waitcnt lgkmcnt(3)
    v_mfma_f32_16x16x32_bf16 v[136:139], v[108:111], a[220:223], v[136:139]
    v_add_f32 v162, 1.0, v162
    v_add_f32 v163, 1.0, v163
    v_rcp_f32 v161, v161
    v_mul_f32 v164, v148, v148
    v_fma_f32 v164, v164, v195, v196
    v_rcp_f32 v162, v162
    s_waitcnt lgkmcnt(2)
    v_mfma_f32_16x16x32_bf16 v[136:139], v[112:115], a[224:227], v[136:139]
    v_mul_f32 v164, v164, v148
    v_mul_f32 v165, v149, v149
    v_rcp_f32 v163, v163
    v_fma_f32 v165, v165, v195, v196
    v_mul_f32 v165, v165, v149
    v_exp_f32 v164, v164
    v_mfma_f32_16x16x32_bf16 v[140:143], v[116:119], a[208:211], 0
    v_mul_f32 v166, v150, v150
    v_fma_f32 v166, v166, v195, v196
    v_exp_f32 v165, v165
    v_mul_f32 v166, v166, v150
    v_mul_f32 v167, v151, v151
    v_exp_f32 v166, v166
    v_mfma_f32_16x16x32_bf16 v[140:143], v[120:123], a[212:215], v[140:143]
    v_fma_f32 v167, v167, v195, v196
    v_mul_f32 v167, v167, v151
    v_exp_f32 v167, v167
    v_add_f32 v164, 1.0, v164
    v_add_f32 v165, 1.0, v165
    v_mfma_f32_16x16x32_bf16 v[140:143], v[124:127], a[216:219], v[140:143]
    v_rcp_f32 v164, v164
    v_add_f32 v166, 1.0, v166
    v_add_f32 v167, 1.0, v167
    v_rcp_f32 v165, v165
    v_mul_f32 v144, v144, v160
    v_mul_f32 v145, v145, v161
    v_mfma_f32_16x16x32_bf16 v[140:143], v[128:131], a[220:223], v[140:143]
    v_rcp_f32 v166, v166
    v_mul_f32 v146, v146, v162
    v_mul_f32 v147, v147, v163
    v_rcp_f32 v167, v167
    v_cvt_pk_bf16_f32 v162, v144, v145
    v_cvt_pk_bf16_f32 v163, v146, v147
    v_mfma_f32_16x16x32_bf16 v[140:143], v[132:135], a[224:227], v[140:143]
    ds_write_b64 v89, v[162:163] offset:0
    v_mul_f32 v148, v148, v164
    v_mul_f32 v149, v149, v165
    v_mul_f32 v150, v150, v166
    v_mul_f32 v151, v151, v167
    v_cvt_pk_bf16_f32 v166, v148, v149
    v_cvt_pk_bf16_f32 v167, v150, v151
    ds_write_b64 v89, v[166:167] offset:32
    v_add_u32 v89, 1152, v89
    s_branch TL_R3E
TL_R3:
    v_mul_f32 v160, v28, v28
    v_fma_f32 v160, v160, v195, v196
    v_mul_f32 v160, v160, v28
    s_waitcnt lgkmcnt(14)
    v_mfma_f32_16x16x32_bf16 v[144:147], v[96:99], a[228:231], 0
    v_exp_f32 v160, v160
    v_mul_f32 v161, v29, v29
    v_fma_f32 v161, v161, v195, v196
    v_mul_f32 v161, v161, v29
    v_exp_f32 v161, v161
    s_mov_b32 s38, 2891776
    v_mul_f32 v162, v30, v30
    v_fma_f32 v162, v162, v195, v196
    v_mul_f32 v162, v162, v30
    v_exp_f32 v162, v162
    v_mul_f32 v163, v31, v31
    s_waitcnt lgkmcnt(13)
    v_mfma_f32_16x16x32_bf16 v[144:147], v[100:103], a[232:235], v[144:147]
    v_fma_f32 v163, v163, v195, v196
    v_mul_f32 v163, v163, v31
    v_exp_f32 v163, v163
    v_add_f32 v160, 1.0, v160
    v_add_f32 v161, 1.0, v161
    v_rcp_f32 v160, v160
    v_add_f32 v162, 1.0, v162
    v_add_f32 v163, 1.0, v163
    v_rcp_f32 v161, v161
    v_mul_f32 v164, v32, v32
    s_waitcnt lgkmcnt(12)
    v_mfma_f32_16x16x32_bf16 v[144:147], v[104:107], a[236:239], v[144:147]
    v_fma_f32 v164, v164, v195, v196
    buffer_load_dwordx4 a[72:75], v1, s[8:11], s38 offen offset:0 sc1
    v_rcp_f32 v162, v162
    v_mul_f32 v164, v164, v32
    v_mul_f32 v165, v33, v33
    v_rcp_f32 v163, v163
    v_fma_f32 v165, v165, v195, v196
    v_mul_f32 v165, v165, v33
    v_exp_f32 v164, v164
    v_mul_f32 v166, v34, v34
    v_fma_f32 v166, v166, v195, v196
    s_waitcnt lgkmcnt(11)
    v_mfma_f32_16x16x32_bf16 v[144:147], v[108:111], a[240:243], v[144:147]
    v_exp_f32 v165, v165
    v_mul_f32 v166, v166, v34
    v_mul_f32 v167, v35, v35
    v_exp_f32 v166, v166
    v_fma_f32 v167, v167, v195, v196
    v_mul_f32 v167, v167, v35
    buffer_load_dwordx4 a[76:79], v1, s[8:11], s38 offen offset:1024 sc1
    v_exp_f32 v167, v167
    v_add_f32 v164, 1.0, v164
    v_add_f32 v165, 1.0, v165
    v_rcp_f32 v164, v164
    s_waitcnt lgkmcnt(10)
    v_mfma_f32_16x16x32_bf16 v[144:147], v[112:115], a[244:247], v[144:147]
    v_add_f32 v166, 1.0, v166
    v_add_f32 v167, 1.0, v167
    v_rcp_f32 v165, v165
    v_mul_f32 v168, v36, v36
    v_fma_f32 v168, v168, v195, v196
    v_rcp_f32 v166, v166
    v_mul_f32 v168, v168, v36
    v_mul_f32 v169, v37, v37
    v_rcp_f32 v167, v167
    v_fma_f32 v169, v169, v195, v196
    s_waitcnt lgkmcnt(9)
    v_mfma_f32_16x16x32_bf16 v[148:151], v[116:119], a[228:231], 0
    v_mul_f32 v169, v169, v37
    buffer_load_dwordx4 a[80:83], v1, s[8:11], s38 offen offset:2048 sc1
    v_exp_f32 v168, v168
    v_mul_f32 v170, v38, v38
    v_fma_f32 v170, v170, v195, v196
    v_exp_f32 v169, v169
    v_mul_f32 v170, v170, v38
    v_mul_f32 v171, v39, v39
    v_exp_f32 v170, v170
    v_fma_f32 v171, v171, v195, v196
    s_waitcnt lgkmcnt(8)
    v_mfma_f32_16x16x32_bf16 v[148:151], v[120:123], a[232:235], v[148:151]
    v_mul_f32 v171, v171, v39
    v_exp_f32 v171, v171
    v_add_f32 v168, 1.0, v168
    v_add_f32 v169, 1.0, v169
    v_rcp_f32 v168, v168
    v_add_f32 v170, 1.0, v170
    v_add_f32 v171, 1.0, v171
    v_rcp_f32 v169, v169
    buffer_load_dwordx4 a[84:87], v1, s[8:11], s38 offen offset:3072 sc1
    v_mul_f32 v28, v28, v160
    v_mul_f32 v29, v29, v161
    s_waitcnt lgkmcnt(7)
    v_mfma_f32_16x16x32_bf16 v[148:151], v[124:127], a[236:239], v[148:151]
    v_rcp_f32 v170, v170
    v_mul_f32 v30, v30, v162
    v_mul_f32 v31, v31, v163
    v_rcp_f32 v171, v171
    v_add_f32 v160, v28, v29
    v_add_f32 v161, v30, v31
    v_fmac_f32 v173, v28, v28
    v_add_f32 v172, v172, v160
    v_fmac_f32 v173, v29, v29
    v_add_f32 v172, v172, v161
    s_waitcnt lgkmcnt(6)
    v_mfma_f32_16x16x32_bf16 v[148:151], v[128:131], a[240:243], v[148:151]
    v_fmac_f32 v173, v30, v30
    v_fmac_f32 v173, v31, v31
    v_mul_f32 v32, v32, v164
    buffer_load_dwordx4 a[88:91], v2, s[8:11], s38 offen offset:0 sc1
    v_mul_f32 v33, v33, v165
    v_mul_f32 v34, v34, v166
    v_mul_f32 v35, v35, v167
    v_add_f32 v164, v32, v33
    v_add_f32 v165, v34, v35
    v_fmac_f32 v175, v32, v32
    v_add_f32 v174, v174, v164
    s_waitcnt lgkmcnt(5)
    v_mfma_f32_16x16x32_bf16 v[148:151], v[132:135], a[244:247], v[148:151]
    v_fmac_f32 v175, v33, v33
    v_add_f32 v174, v174, v165
    v_fmac_f32 v175, v34, v34
    v_fmac_f32 v175, v35, v35
    v_mul_f32 v36, v36, v168
    v_mul_f32 v37, v37, v169
    v_mul_f32 v38, v38, v170
    v_mul_f32 v39, v39, v171
    v_add_f32 v168, v36, v37
    v_add_f32 v169, v38, v39
    v_fmac_f32 v177, v36, v36
    v_add_f32 v176, v176, v168
    v_fmac_f32 v177, v37, v37
    v_add_f32 v176, v176, v169
    v_fmac_f32 v177, v38, v38
    v_fmac_f32 v177, v39, v39
    v_mul_f32 v160, v144, v144
    v_fma_f32 v160, v160, v195, v196
    s_waitcnt lgkmcnt(4)
    v_mfma_f32_16x16x32_bf16 v[136:139], v[96:99], a[188:191], 0
    v_mul_f32 v160, v160, v144
    buffer_load_dwordx4 a[92:95], v2, s[8:11], s38 offen offset:1024 sc1
    v_exp_f32 v160, v160
    v_mul_f32 v161, v145, v145
    v_fma_f32 v161, v161, v195, v196
    v_mul_f32 v161, v161, v145
    v_exp_f32 v161, v161
    s_waitcnt lgkmcnt(3)
    v_mfma_f32_16x16x32_bf16 v[136:139], v[100:103], a[192:195], v[136:139]
    buffer_load_dwordx4 a[96:99], v2, s[8:11], s38 offen offset:2048 sc1
    v_mul_f32 v162, v146, v146
    v_fma_f32 v162, v162, v195, v196
    v_mul_f32 v162, v162, v146
    v_exp_f32 v162, v162
    v_mul_f32 v163, v147, v147
    buffer_load_dwordx4 a[100:103], v2, s[8:11], s38 offen offset:3072 sc1
    v_fma_f32 v163, v163, v195, v196
    s_waitcnt lgkmcnt(2)
    v_mfma_f32_16x16x32_bf16 v[136:139], v[104:107], a[196:199], v[136:139]
    v_mul_f32 v163, v163, v147
    v_exp_f32 v163, v163
    v_add_f32 v160, 1.0, v160
    buffer_load_dwordx4 a[104:107], v3, s[8:11], s38 offen offset:0 sc1
    v_add_f32 v161, 1.0, v161
    v_rcp_f32 v160, v160
    s_waitcnt lgkmcnt(1)
    v_mfma_f32_16x16x32_bf16 v[136:139], v[108:111], a[200:203], v[136:139]
    v_add_f32 v162, 1.0, v162
    v_add_f32 v163, 1.0, v163
    v_rcp_f32 v161, v161
    s_add_u32 s33, s31, 0
    v_mul_f32 v164, v148, v148
    v_fma_f32 v164, v164, v195, v196
    v_rcp_f32 v162, v162
    s_waitcnt lgkmcnt(0)
    v_mfma_f32_16x16x32_bf16 v[136:139], v[112:115], a[204:207], v[136:139]
    v_mul_f32 v164, v164, v148
    v_mul_f32 v165, v149, v149
    buffer_load_dwordx4 a[128:131], v93, s[8:11], s33 offen sc1
    v_rcp_f32 v163, v163
    v_fma_f32 v165, v165, v195, v196
    v_mul_f32 v165, v165, v149
    v_exp_f32 v164, v164
    v_mfma_f32_16x16x32_bf16 v[140:143], v[116:119], a[188:191], 0
    v_mul_f32 v166, v150, v150
    buffer_load_dwordx4 a[132:135], v93, s[8:11], s33 offen offset:16 sc1
    v_fma_f32 v166, v166, v195, v196
    v_exp_f32 v165, v165
    v_mul_f32 v166, v166, v150
    v_mul_f32 v167, v151, v151
    v_exp_f32 v166, v166
    v_mfma_f32_16x16x32_bf16 v[140:143], v[120:123], a[192:195], v[140:143]
    buffer_load_dwordx2 a[136:137], v93, s[8:11], s33 offen offset:32 sc1
    v_fma_f32 v167, v167, v195, v196
    v_mul_f32 v167, v167, v151
    v_exp_f32 v167, v167
    v_add_f32 v164, 1.0, v164
    v_add_f32 v165, 1.0, v165
    v_mfma_f32_16x16x32_bf16 v[140:143], v[124:127], a[196:199], v[140:143]
    s_add_u32 s33, s31, 2560
    v_rcp_f32 v164, v164
    v_add_f32 v166, 1.0, v166
    v_add_f32 v167, 1.0, v167
    v_rcp_f32 v165, v165
    v_mul_f32 v144, v144, v160
    buffer_load_dwordx4 a[138:141], v93, s[8:11], s33 offen sc1
    v_mul_f32 v145, v145, v161
    v_mfma_f32_16x16x32_bf16 v[140:143], v[128:131], a[200:203], v[140:143]
    v_rcp_f32 v166, v166
    v_mul_f32 v146, v146, v162
    v_mul_f32 v147, v147, v163
    buffer_load_dwordx4 a[142:145], v93, s[8:11], s33 offen offset:16 sc1
    v_rcp_f32 v167, v167
    v_cvt_pk_bf16_f32 v162, v144, v145
    v_cvt_pk_bf16_f32 v163, v146, v147
    v_mfma_f32_16x16x32_bf16 v[140:143], v[132:135], a[204:207], v[140:143]
    ds_write_b64 v89, v[162:163] offset:0
    v_mul_f32 v148, v148, v164
    buffer_load_dwordx2 a[146:147], v93, s[8:11], s33 offen offset:32 sc1
    v_mul_f32 v149, v149, v165
    v_mul_f32 v150, v150, v166
    v_mul_f32 v151, v151, v167
    v_cvt_pk_bf16_f32 v166, v148, v149
    v_cvt_pk_bf16_f32 v167, v150, v151
    ds_write_b64 v89, v[166:167] offset:32
    v_add_u32 v89, 1152, v89
TL_R3E:
TL_RJ:
    v_mul_f32 v160, v136, v136
    v_fma_f32 v160, v160, v195, v196
    v_mul_f32 v160, v160, v136
    v_exp_f32 v160, v160
    v_mul_f32 v161, v137, v137
    v_fma_f32 v161, v161, v195, v196
    v_mul_f32 v161, v161, v137
    v_exp_f32 v161, v161
    v_mul_f32 v162, v138, v138
    v_fma_f32 v162, v162, v195, v196
    v_mul_f32 v162, v162, v138
    v_exp_f32 v162, v162
    v_mul_f32 v163, v139, v139
    v_fma_f32 v163, v163, v195, v196
    v_mul_f32 v163, v163, v139
    v_exp_f32 v163, v163
    v_add_f32 v160, 1.0, v160
    v_add_f32 v161, 1.0, v161
    v_rcp_f32 v160, v160
    v_add_f32 v162, 1.0, v162
    v_add_f32 v163, 1.0, v163
    v_rcp_f32 v161, v161
    v_mul_f32 v164, v140, v140
    v_fma_f32 v164, v164, v195, v196
    v_rcp_f32 v162, v162
    v_mul_f32 v164, v164, v140
    v_mul_f32 v165, v141, v141
    v_rcp_f32 v163, v163
    v_fma_f32 v165, v165, v195, v196
    v_mul_f32 v165, v165, v141
    v_exp_f32 v164, v164
    v_mul_f32 v166, v142, v142
    v_fma_f32 v166, v166, v195, v196
    v_exp_f32 v165, v165
    v_mul_f32 v166, v166, v142
    v_mul_f32 v167, v143, v143
    v_exp_f32 v166, v166
    v_fma_f32 v167, v167, v195, v196
    v_mul_f32 v167, v167, v143
    v_exp_f32 v167, v167
    v_add_f32 v164, 1.0, v164
    v_add_f32 v165, 1.0, v165
    v_rcp_f32 v164, v164
    v_add_f32 v166, 1.0, v166
    v_add_f32 v167, 1.0, v167
    v_rcp_f32 v165, v165
    v_mul_f32 v136, v136, v160
    v_mul_f32 v137, v137, v161
    v_rcp_f32 v166, v166
    v_mul_f32 v138, v138, v162
    v_mul_f32 v139, v139, v163
    v_rcp_f32 v167, v167
    v_cvt_pk_bf16_f32 v162, v136, v137
    v_cvt_pk_bf16_f32 v163, v138, v139
    ds_write_b64 v89, v[162:163] offset:0
    v_mul_f32 v140, v140, v164
    v_mul_f32 v141, v141, v165
    v_mul_f32 v142, v142, v166
    v_mul_f32 v143, v143, v167
    v_cvt_pk_bf16_f32 v166, v140, v141
    v_cvt_pk_bf16_f32 v167, v142, v143
    ds_write_b64 v89, v[166:167] offset:32
    v_add_u32 v11, s26, v9
    v_mul_u32_u24 v11, 288, v11
    v_lshl_add_u32 v12, v10, 4, v11
    s_lshl_b32 s3, s19, 6
    v_add_u32 v12, s3, v12
    buffer_load_dwordx4 v[198:201], v12, s[40:43], 0 offen
    v_add_u32 v13, 4608, v12
    buffer_load_dwordx4 v[202:205], v13, s[40:43], 0 offen
    s_and_b32 s3, s73, 1
    s_mul_i32 s3, s3, 4608
    v_lshl_add_u32 v14, v10, 3, v11
    v_add_u32 v14, s3, v14
    buffer_load_dwordx2 v[206:207], v14, s[40:43], 0 offen offset:256
    s_cmp_lt_u32 s73, 2
    s_cbranch_scc1 TL_NOSMP
    s_xor_b32 s3, s17, 1
    s_add_u32 s33, s34, s3
    s_lshl_b32 s3, s33, 6
    s_add_u32 s3, s3, 8454144
    v_mov_b32 v15, s3
    buffer_load_dword v14, v15, s[8:11], 0 offen sc1
    v_mul_u32_u24 v184, 592, v9
    v_lshl_add_u32 v184, v10, 4, v184
    v_bfe_u32 v192, v0, 2, 2
    v_lshl_add_u32 v192, v10, 3, v192
    v_mul_u32_u24 v192, 72, v192
    v_and_b32 v193, 3, v0
    v_lshl_add_u32 v192, v193, 3, v192
    v_add_u32 v185, 137856, v192
    s_mul_i32 s39, s16, 1152000
    s_and_b32 s3, s73, 1
    s_mul_i32 s21, s3, 9472
    v_add_u32 v186, s21, v184
    s_lshl_b32 s3, s3, 5
    v_add_u32 v187, s3, v185
    v_add_u32 v190, s26, v9
    v_mul_u32_u24 v190, 288, v190
    v_lshl_add_u32 v188, v10, 4, v190
    s_lshl_b32 s3, s19, 6
    v_add_u32 v188, s3, v188
    v_add_u32 v189, 4608, v188
    v_mul_u32_u24 v191, 592, v9
    v_lshl_add_u32 v191, v10, 3, v191
    s_and_b32 s3, s19, 1
    s_mul_i32 s3, s3, 9472
    s_add_u32 s3, s3, 0
    v_add_u32 v191, s3, v191
TL_NOSMP:
    v_lshlrev_b32 v160, 3, v9
    s_mul_i32 s3, s19, 384
    s_add_u32 s3, s3, 25600
    v_permlane16_swap_b32 v172, v173
    v_permlane16_swap_b32 v174, v175
    v_permlane16_swap_b32 v176, v177
    v_and_b32 v162, 1, v10
    v_lshl_add_u32 v161, v162, 2, v160
    v_add_u32 v161, s3, v161
    v_add_f32 v172, v172, v173
    v_add_f32 v174, v174, v175
    v_add_f32 v176, v176, v177
    v_mov_b32 v177, v176
    v_lshrrev_b32 v162, 1, v10
    v_lshl_add_u32 v162, v162, 7, v161
    v_permlane32_swap_b32 v172, v174
    v_permlane32_swap_b32 v176, v177
    v_add_f32 v172, v172, v174
    v_add_f32 v176, v176, v177
    ds_write_b32 v162, v172
    ds_write_b32 v161, v176 offset:256
    v_add_u32 v160, 25600, v160
    s_waitcnt lgkmcnt(0)
    s_barrier
    ds_read_b64 v[52:53], v160 offset:0
    ds_read_b64 v[54:55], v160 offset:384
    ds_read_b64 v[56:57], v160 offset:768
    ds_read_b64 v[58:59], v160 offset:1152
    ds_read_b64 v[60:61], v160 offset:128
    ds_read_b64 v[62:63], v160 offset:512
    ds_read_b64 v[64:65], v160 offset:896
    ds_read_b64 v[66:67], v160 offset:1280
    ds_read_b64 v[68:69], v160 offset:256
    ds_read_b64 v[70:71], v160 offset:640
    ds_read_b64 v[72:73], v160 offset:1024
    ds_read_b64 v[74:75], v160 offset:1408
    v_mov_b32 v162, 0x3be38e39
    s_waitcnt lgkmcnt(10)
    v_add_f32 v52, v52, v54
    v_add_f32 v53, v53, v55
    s_waitcnt lgkmcnt(8)
    v_add_f32 v56, v56, v58
    v_add_f32 v57, v57, v59
    v_add_f32 v52, v52, v56
    v_add_f32 v53, v53, v57
    v_mul_f32 v52, v52, v162
    v_mul_f32 v54, v52, v52
    v_fma_f32 v53, v53, v162, -v54
    v_max_f32 v53, 0, v53
    v_add_f32 v53, 0x3727c5ac, v53
    s_waitcnt lgkmcnt(6)
    v_add_f32 v60, v60, v62
    v_add_f32 v61, v61, v63
    s_waitcnt lgkmcnt(4)
    v_add_f32 v64, v64, v66
    v_add_f32 v65, v65, v67
    v_add_f32 v60, v60, v64
    v_add_f32 v61, v61, v65
    v_mul_f32 v60, v60, v162
    v_mul_f32 v62, v60, v60
    v_fma_f32 v61, v61, v162, -v62
    v_max_f32 v61, 0, v61
    v_add_f32 v61, 0x3727c5ac, v61
    s_waitcnt lgkmcnt(2)
    v_add_f32 v68, v68, v70
    v_add_f32 v69, v69, v71
    s_waitcnt lgkmcnt(0)
    v_add_f32 v72, v72, v74
    v_add_f32 v73, v73, v75
    v_add_f32 v68, v68, v72
    v_add_f32 v69, v69, v73
    v_mul_f32 v68, v68, v162
    v_mul_f32 v70, v68, v68
    v_fma_f32 v69, v69, v162, -v70
    v_max_f32 v69, 0, v69
    v_add_f32 v69, 0x3727c5ac, v69
    v_rsq_f32 v178, v53
    v_rsq_f32 v180, v61
    v_rsq_f32 v182, v69
    v_mul_f32 v179, v52, v178
    v_sub_f32 v179, 0, v179
    v_mul_f32 v181, v60, v180
    v_sub_f32 v181, 0, v181
    v_mul_f32 v183, v68, v182
    v_sub_f32 v183, 0, v183
    s_cmp_lt_u32 s73, 2
    s_cbranch_scc1 TL_NOREC
    s_mov_b64 s[28:29], 1
    s_waitcnt vmcnt(0)
    v_cmp_ne_u32 vcc, s64, v14
    s_nop 1
    s_and_b64 vcc, vcc, s[28:29]
    s_nop 1
    s_cbranch_vccz CHK6
    s_mov_b64 exec, s[28:29]
    s_mov_b32 s65, 0
POLL6:
    buffer_load_dword v14, v15, s[8:11], 0 offen sc1
POLLC6:
    s_waitcnt vmcnt(0)
    v_cmp_ne_u32 vcc, s64, v14
    s_add_u32 s65, s65, 1
    s_nop 3
    s_cbranch_vccz POLLD6
    s_sleep 1
    s_cmp_lt_u32 s65, 65536
    s_cbranch_scc1 POLL6
POLLD6:
    s_mov_b64 exec, -1
CHK6:
    s_mul_i32 s21, s33, 5120
    s_add_u32 s21, s21, 3145728
    buffer_load_dwordx4 a[108:111], v1, s[8:11], s21 offen offset:0 sc1
    buffer_load_dwordx4 a[112:115], v1, s[8:11], s21 offen offset:1024 sc1
    buffer_load_dwordx4 a[116:119], v1, s[8:11], s21 offen offset:2048 sc1
    buffer_load_dwordx4 a[120:123], v1, s[8:11], s21 offen offset:3072 sc1
    buffer_load_dwordx4 a[124:127], v2, s[8:11], s21 offen sc1
TL_NOREC:
    v_fma_f32 v16, v16, v178, v179
    v_fma_f32 v17, v17, v178, v179
    v_fma_f32 v18, v18, v178, v179
    v_fma_f32 v19, v19, v178, v179
    v_cvt_pk_bf16_f32 v160, v16, v17
    v_cvt_pk_bf16_f32 v161, v18, v19
    ds_write_b16 v90, v160 offset:0
    ds_write_b16_d16_hi v90, v160 offset:104
    ds_write_b16 v90, v161 offset:208
    ds_write_b16_d16_hi v90, v161 offset:312
    v_fma_f32 v20, v20, v180, v181
    v_fma_f32 v21, v21, v180, v181
    v_fma_f32 v22, v22, v180, v181
    v_fma_f32 v23, v23, v180, v181
    v_cvt_pk_bf16_f32 v162, v20, v21
    v_cvt_pk_bf16_f32 v163, v22, v23
    ds_write_b16 v90, v162 offset:32
    ds_write_b16_d16_hi v90, v162 offset:136
    ds_write_b16 v90, v163 offset:240
    ds_write_b16_d16_hi v90, v163 offset:344
    v_fma_f32 v24, v24, v182, v183
    v_fma_f32 v25, v25, v182, v183
    v_fma_f32 v26, v26, v182, v183
    v_fma_f32 v27, v27, v182, v183
    v_cvt_pk_bf16_f32 v160, v24, v25
    v_cvt_pk_bf16_f32 v161, v26, v27
    ds_write_b16 v90, v160 offset:64
    ds_write_b16_d16_hi v90, v160 offset:168
    ds_write_b16 v90, v161 offset:272
    ds_write_b16_d16_hi v90, v161 offset:376
    v_fma_f32 v28, v28, v178, v179
    v_fma_f32 v29, v29, v178, v179
    v_fma_f32 v30, v30, v178, v179
    v_fma_f32 v31, v31, v178, v179
    v_cvt_pk_bf16_f32 v160, v28, v29
    v_cvt_pk_bf16_f32 v161, v30, v31
    ds_write_b16 v90, v160 offset:1664
    ds_write_b16_d16_hi v90, v160 offset:1768
    ds_write_b16 v90, v161 offset:1872
    ds_write_b16_d16_hi v90, v161 offset:1976
    v_fma_f32 v32, v32, v180, v181
    v_fma_f32 v33, v33, v180, v181
    v_fma_f32 v34, v34, v180, v181
    v_fma_f32 v35, v35, v180, v181
    v_cvt_pk_bf16_f32 v162, v32, v33
    v_cvt_pk_bf16_f32 v163, v34, v35
    ds_write_b16 v90, v162 offset:1696
    ds_write_b16_d16_hi v90, v162 offset:1800
    ds_write_b16 v90, v163 offset:1904
    ds_write_b16_d16_hi v90, v163 offset:2008
    v_fma_f32 v36, v36, v182, v183
    v_fma_f32 v37, v37, v182, v183
    v_fma_f32 v38, v38, v182, v183
    v_fma_f32 v39, v39, v182, v183
    v_cvt_pk_bf16_f32 v160, v36, v37
    v_cvt_pk_bf16_f32 v161, v38, v39
    ds_write_b16 v90, v160 offset:1728
    ds_write_b16_d16_hi v90, v160 offset:1832
    ds_write_b16 v90, v161 offset:1936
    ds_write_b16_d16_hi v90, v161 offset:2040
    s_cmp_lg_u32 s73, 0
    s_cbranch_scc1 TL_NON2
    v_fma_f32 v40, v40, v178, v179
    v_fma_f32 v41, v41, v178, v179
    v_fma_f32 v42, v42, v178, v179
    v_fma_f32 v43, v43, v178, v179
    v_cvt_pk_bf16_f32 v160, v40, v41
    v_cvt_pk_bf16_f32 v161, v42, v43
    ds_write_b16 v90, v160 offset:3328
    ds_write_b16_d16_hi v90, v160 offset:3432
    ds_write_b16 v90, v161 offset:3536
    ds_write_b16_d16_hi v90, v161 offset:3640
    v_fma_f32 v44, v44, v180, v181
    v_fma_f32 v45, v45, v180, v181
    v_fma_f32 v46, v46, v180, v181
    v_fma_f32 v47, v47, v180, v181
    v_cvt_pk_bf16_f32 v162, v44, v45
    v_cvt_pk_bf16_f32 v163, v46, v47
    ds_write_b16 v90, v162 offset:3360
    ds_write_b16_d16_hi v90, v162 offset:3464
    ds_write_b16 v90, v163 offset:3568
    ds_write_b16_d16_hi v90, v163 offset:3672
    v_fma_f32 v48, v48, v182, v183
    v_fma_f32 v49, v49, v182, v183
    v_fma_f32 v50, v50, v182, v183
    v_fma_f32 v51, v51, v182, v183
    v_cvt_pk_bf16_f32 v160, v48, v49
    v_cvt_pk_bf16_f32 v161, v50, v51
    ds_write_b16 v90, v160 offset:3392
    ds_write_b16_d16_hi v90, v160 offset:3496
    ds_write_b16 v90, v161 offset:3600
    ds_write_b16_d16_hi v90, v161 offset:3704
TL_NON2:
    s_waitcnt lgkmcnt(12)
    ds_read_b64 v[52:53], v91 offset:0
    ds_read_b64 v[54:55], v91 offset:8
    ds_read_b64 v[56:57], v91 offset:16
    ds_read_b64 v[58:59], v91 offset:24
    ds_read_b64 v[60:61], v91 offset:32
    ds_read_b64 v[62:63], v91 offset:40
    ds_read_b64 v[64:65], v91 offset:48
    ds_read_b64 v[66:67], v91 offset:56
    ds_read_b64 v[68:69], v91 offset:64
    ds_read_b64 v[80:81], v92 offset:0
    ds_read_b64 v[82:83], v92 offset:32
    s_waitcnt vmcnt(9) lgkmcnt(10)
    v_mfma_f32_4x4x4_16b_bf16 v[72:75], a[128:129], v[52:53], 0
    s_waitcnt lgkmcnt(6)
    v_mfma_f32_4x4x4_16b_bf16 v[76:79], a[128:129], v[60:61], 0
    v_mfma_f32_4x4x4_16b_bf16 v[72:75], a[130:131], v[54:55], v[72:75]
    s_waitcnt lgkmcnt(5)
    v_mfma_f32_4x4x4_16b_bf16 v[76:79], a[130:131], v[62:63], v[76:79]
    s_waitcnt vmcnt(8)
    v_mfma_f32_4x4x4_16b_bf16 v[72:75], a[132:133], v[56:57], v[72:75]
    s_waitcnt lgkmcnt(4)
    v_mfma_f32_4x4x4_16b_bf16 v[76:79], a[132:133], v[64:65], v[76:79]
    v_mfma_f32_4x4x4_16b_bf16 v[72:75], a[134:135], v[58:59], v[72:75]
    s_waitcnt lgkmcnt(3)
    v_mfma_f32_4x4x4_16b_bf16 v[76:79], a[134:135], v[66:67], v[76:79]
    s_waitcnt vmcnt(7)
    v_mfma_f32_4x4x4_16b_bf16 v[72:75], a[136:137], v[60:61], v[72:75]
    s_waitcnt lgkmcnt(2)
    v_mfma_f32_4x4x4_16b_bf16 v[76:79], a[136:137], v[68:69], v[76:79]
    s_waitcnt lgkmcnt(1)
    v_lshlrev_b32 v84, 16, v80
    v_and_b32 v85, 0xffff0000, v80
    s_nop 2
    v_mul_f32 v84, v84, v72
    v_mul_f32 v85, v85, v73
    v_cvt_pk_bf16_f32 v80, v84, v85
    v_lshlrev_b32 v84, 16, v81
    v_and_b32 v85, 0xffff0000, v81
    v_mul_f32 v84, v84, v74
    v_mul_f32 v85, v85, v75
    v_cvt_pk_bf16_f32 v81, v84, v85
    s_waitcnt lgkmcnt(0)
    v_lshlrev_b32 v84, 16, v82
    v_and_b32 v85, 0xffff0000, v82
    v_mul_f32 v84, v84, v76
    v_mul_f32 v85, v85, v77
    v_cvt_pk_bf16_f32 v82, v84, v85
    v_lshlrev_b32 v84, 16, v83
    v_and_b32 v85, 0xffff0000, v83
    v_mul_f32 v84, v84, v78
    v_mul_f32 v85, v85, v79
    v_cvt_pk_bf16_f32 v83, v84, v85
    ds_write_b64 v92, v[80:81] offset:0
    ds_write_b64 v92, v[82:83] offset:32
    ds_read_b64 v[52:53], v91 offset:1664
    ds_read_b64 v[54:55], v91 offset:1672
    ds_read_b64 v[56:57], v91 offset:1680
    ds_read_b64 v[58:59], v91 offset:1688
    ds_read_b64 v[60:61], v91 offset:1696
    ds_read_b64 v[62:63], v91 offset:1704
    ds_read_b64 v[64:65], v91 offset:1712
    ds_read_b64 v[66:67], v91 offset:1720
    ds_read_b64 v[68:69], v91 offset:1728
    ds_read_b64 v[80:81], v92 offset:1152
    ds_read_b64 v[82:83], v92 offset:1184
    s_waitcnt vmcnt(6) lgkmcnt(10)
    v_mfma_f32_4x4x4_16b_bf16 v[72:75], a[138:139], v[52:53], 0
    s_waitcnt lgkmcnt(6)
    v_mfma_f32_4x4x4_16b_bf16 v[76:79], a[138:139], v[60:61], 0
    v_mfma_f32_4x4x4_16b_bf16 v[72:75], a[140:141], v[54:55], v[72:75]
    s_waitcnt lgkmcnt(5)
    v_mfma_f32_4x4x4_16b_bf16 v[76:79], a[140:141], v[62:63], v[76:79]
    s_waitcnt vmcnt(5)
    v_mfma_f32_4x4x4_16b_bf16 v[72:75], a[142:143], v[56:57], v[72:75]
    s_waitcnt lgkmcnt(4)
    v_mfma_f32_4x4x4_16b_bf16 v[76:79], a[142:143], v[64:65], v[76:79]
    v_mfma_f32_4x4x4_16b_bf16 v[72:75], a[144:145], v[58:59], v[72:75]
    s_waitcnt lgkmcnt(3)
    v_mfma_f32_4x4x4_16b_bf16 v[76:79], a[144:145], v[66:67], v[76:79]
    s_waitcnt vmcnt(4)
    v_mfma_f32_4x4x4_16b_bf16 v[72:75], a[146:147], v[60:61], v[72:75]
    s_waitcnt lgkmcnt(2)
    v_mfma_f32_4x4x4_16b_bf16 v[76:79], a[146:147], v[68:69], v[76:79]
    s_waitcnt lgkmcnt(1)
    v_lshlrev_b32 v84, 16, v80
    v_and_b32 v85, 0xffff0000, v80
    s_nop 2
    v_mul_f32 v84, v84, v72
    v_mul_f32 v85, v85, v73
    v_cvt_pk_bf16_f32 v80, v84, v85
    v_lshlrev_b32 v84, 16, v81
    v_and_b32 v85, 0xffff0000, v81
    v_mul_f32 v84, v84, v74
    v_mul_f32 v85, v85, v75
    v_cvt_pk_bf16_f32 v81, v84, v85
    s_waitcnt lgkmcnt(0)
    v_lshlrev_b32 v84, 16, v82
    v_and_b32 v85, 0xffff0000, v82
    v_mul_f32 v84, v84, v76
    v_mul_f32 v85, v85, v77
    v_cvt_pk_bf16_f32 v82, v84, v85
    v_lshlrev_b32 v84, 16, v83
    v_and_b32 v85, 0xffff0000, v83
    v_mul_f32 v84, v84, v78
    v_mul_f32 v85, v85, v79
    v_cvt_pk_bf16_f32 v83, v84, v85
    s_cmp_lg_u32 s73, 3
    s_cbranch_scc1 TL_NG8
    v_and_b32 v84, 3, v0
    v_mul_u32_u24 v84, 2368, v84
    v_lshrrev_b32 v85, 2, v0
    v_lshl_add_u32 v84, v85, 1, v84
    ds_write_b16 v84, v80 offset:288
    ds_write_b16_d16_hi v84, v80 offset:880
    ds_write_b16 v84, v81 offset:1472
    ds_write_b16_d16_hi v84, v81 offset:2064
    ds_write_b16 v84, v82 offset:9760
    ds_write_b16_d16_hi v84, v82 offset:10352
    ds_write_b16 v84, v83 offset:10944
    ds_write_b16_d16_hi v84, v83 offset:11536
    s_branch TL_NG8E
TL_NG8:
    ds_write_b64 v92, v[80:81] offset:1152
    ds_write_b64 v92, v[82:83] offset:1184
TL_NG8E:
    s_cmp_lg_u32 s73, 0
    s_cbranch_scc1 TL_NOC2
    ds_read_b64 v[52:53], v91 offset:3328
    ds_read_b64 v[54:55], v91 offset:3336
    ds_read_b64 v[56:57], v91 offset:3344
    ds_read_b64 v[58:59], v91 offset:3352
    ds_read_b64 v[60:61], v91 offset:3360
    ds_read_b64 v[62:63], v91 offset:3368
    ds_read_b64 v[64:65], v91 offset:3376
    ds_read_b64 v[66:67], v91 offset:3384
    ds_read_b64 v[68:69], v91 offset:3392
    ds_read_b64 v[80:81], v92 offset:2304
    ds_read_b64 v[82:83], v92 offset:2336
    s_waitcnt lgkmcnt(10)
    v_mfma_f32_4x4x4_16b_bf16 v[72:75], a[148:149], v[52:53], 0
    s_waitcnt lgkmcnt(6)
    v_mfma_f32_4x4x4_16b_bf16 v[76:79], a[148:149], v[60:61], 0
    v_mfma_f32_4x4x4_16b_bf16 v[72:75], a[150:151], v[54:55], v[72:75]
    s_waitcnt lgkmcnt(5)
    v_mfma_f32_4x4x4_16b_bf16 v[76:79], a[150:151], v[62:63], v[76:79]
    v_mfma_f32_4x4x4_16b_bf16 v[72:75], a[152:153], v[56:57], v[72:75]
    s_waitcnt lgkmcnt(4)
    v_mfma_f32_4x4x4_16b_bf16 v[76:79], a[152:153], v[64:65], v[76:79]
    v_mfma_f32_4x4x4_16b_bf16 v[72:75], a[154:155], v[58:59], v[72:75]
    s_waitcnt lgkmcnt(3)
    v_mfma_f32_4x4x4_16b_bf16 v[76:79], a[154:155], v[66:67], v[76:79]
    s_waitcnt vmcnt(3)
    v_mfma_f32_4x4x4_16b_bf16 v[72:75], a[156:157], v[60:61], v[72:75]
    s_waitcnt lgkmcnt(2)
    v_mfma_f32_4x4x4_16b_bf16 v[76:79], a[156:157], v[68:69], v[76:79]
    s_waitcnt lgkmcnt(1)
    v_lshlrev_b32 v84, 16, v80
    v_and_b32 v85, 0xffff0000, v80
    s_nop 2
    v_mul_f32 v84, v84, v72
    v_mul_f32 v85, v85, v73
    v_cvt_pk_bf16_f32 v80, v84, v85
    v_lshlrev_b32 v84, 16, v81
    v_and_b32 v85, 0xffff0000, v81
    v_mul_f32 v84, v84, v74
    v_mul_f32 v85, v85, v75
    v_cvt_pk_bf16_f32 v81, v84, v85
    s_waitcnt lgkmcnt(0)
    v_lshlrev_b32 v84, 16, v82
    v_and_b32 v85, 0xffff0000, v82
    v_mul_f32 v84, v84, v76
    v_mul_f32 v85, v85, v77
    v_cvt_pk_bf16_f32 v82, v84, v85
    v_lshlrev_b32 v84, 16, v83
    v_and_b32 v85, 0xffff0000, v83
    v_mul_f32 v84, v84, v78
    v_mul_f32 v85, v85, v79
    v_cvt_pk_bf16_f32 v83, v84, v85
    ds_write_b64 v92, v[80:81] offset:2304
    ds_write_b64 v92, v[82:83] offset:2336
TL_NOC2:
    s_cmp_lt_u32 s73, 2
    s_cbranch_scc1 TL_NORECV
    s_waitcnt vmcnt(0)
    v_mfma_f32_16x16x32_bf16 v[252:255], v[208:211], a[124:127], v[252:255]
    v_mfma_f32_16x16x32_bf16 v[248:251], v[210:213], a[124:127], v[248:251]
    v_mfma_f32_16x16x32_bf16 v[216:219], v[210:213], a[108:111], v[216:219]
    v_mfma_f32_16x16x32_bf16 v[220:223], v[208:211], a[108:111], v[220:223]
    s_nop 4
    v_add_f32 v56, v252, v253
    v_mfma_f32_16x16x32_bf16 v[224:227], v[210:213], a[112:115], v[224:227]
    v_mov_b32 v57, v56
    v_mfma_f32_16x16x32_bf16 v[228:231], v[208:211], a[112:115], v[228:231]
    s_nop 0
    v_permlane16_swap_b32 v56, v57
    v_mfma_f32_16x16x32_bf16 v[232:235], v[210:213], a[116:119], v[232:235]
    v_add_f32 v56, v56, v57
    v_mfma_f32_16x16x32_bf16 v[236:239], v[208:211], a[116:119], v[236:239]
    v_mov_b32 v57, v56
    v_mfma_f32_16x16x32_bf16 v[240:243], v[210:213], a[120:123], v[240:243]
    s_nop 0
    v_permlane32_swap_b32 v56, v57
    v_mfma_f32_16x16x32_bf16 v[244:247], v[208:211], a[120:123], v[244:247]
    v_add_f32 v56, v56, v57
    v_rcp_f32 v56, v56
    s_nop 0
    v_mul_f32 v216, v216, v56
    v_mul_f32 v217, v217, v56
    v_mul_f32 v218, v218, v56
    v_mul_f32 v219, v219, v56
    v_cvt_pk_bf16_f32 v64, v216, v217
    v_cvt_pk_bf16_f32 v65, v218, v219
    ds_write_b64 v191, v[64:65] offset:0
    v_mul_f32 v220, v220, v56
    v_mul_f32 v221, v221, v56
    v_mul_f32 v222, v222, v56
    v_mul_f32 v223, v223, v56
    v_cvt_pk_bf16_f32 v66, v220, v221
    v_cvt_pk_bf16_f32 v67, v222, v223
    ds_write_b64 v191, v[66:67] offset:32
    v_mul_f32 v224, v224, v56
    v_mul_f32 v225, v225, v56
    v_mul_f32 v226, v226, v56
    v_mul_f32 v227, v227, v56
    v_cvt_pk_bf16_f32 v64, v224, v225
    v_cvt_pk_bf16_f32 v65, v226, v227
    ds_write_b64 v191, v[64:65] offset:64
    v_mul_f32 v228, v228, v56
    v_mul_f32 v229, v229, v56
    v_mul_f32 v230, v230, v56
    v_mul_f32 v231, v231, v56
    v_cvt_pk_bf16_f32 v66, v228, v229
    v_cvt_pk_bf16_f32 v67, v230, v231
    ds_write_b64 v191, v[66:67] offset:96
    v_mul_f32 v232, v232, v56
    v_mul_f32 v233, v233, v56
    v_mul_f32 v234, v234, v56
    v_mul_f32 v235, v235, v56
    v_cvt_pk_bf16_f32 v64, v232, v233
    v_cvt_pk_bf16_f32 v65, v234, v235
    ds_write_b64 v191, v[64:65] offset:128
    v_mul_f32 v236, v236, v56
    v_mul_f32 v237, v237, v56
    v_mul_f32 v238, v238, v56
    v_mul_f32 v239, v239, v56
    v_cvt_pk_bf16_f32 v66, v236, v237
    v_cvt_pk_bf16_f32 v67, v238, v239
    ds_write_b64 v191, v[66:67] offset:160
    v_mul_f32 v240, v240, v56
    v_mul_f32 v241, v241, v56
    v_mul_f32 v242, v242, v56
    v_mul_f32 v243, v243, v56
    v_cvt_pk_bf16_f32 v64, v240, v241
    v_cvt_pk_bf16_f32 v65, v242, v243
    ds_write_b64 v191, v[64:65] offset:192
    v_mul_f32 v244, v244, v56
    v_mul_f32 v245, v245, v56
    v_mul_f32 v246, v246, v56
    v_mul_f32 v247, v247, v56
    v_cvt_pk_bf16_f32 v66, v244, v245
    v_cvt_pk_bf16_f32 v67, v246, v247
    ds_write_b64 v191, v[66:67] offset:224
    v_mul_f32 v248, v248, v56
    v_mul_f32 v249, v249, v56
    v_mul_f32 v250, v250, v56
    v_mul_f32 v251, v251, v56
    v_cvt_pk_bf16_f32 v64, v248, v249
    v_cvt_pk_bf16_f32 v65, v250, v251
    ds_write_b64 v191, v[64:65] offset:256
TL_NORECV:
    s_cmp_ge_u32 s73, 2
    s_cbranch_scc1 TL_NOFS
    v_mul_u32_u24 v184, 592, v9
    v_lshl_add_u32 v184, v10, 4, v184
    v_bfe_u32 v192, v0, 2, 2
    v_lshl_add_u32 v192, v10, 3, v192
    v_mul_u32_u24 v192, 72, v192
    v_and_b32 v193, 3, v0
    v_lshl_add_u32 v192, v193, 3, v192
    v_add_u32 v185, 137856, v192
    s_mul_i32 s39, s16, 1152000
    s_and_b32 s3, s73, 1
    s_mul_i32 s21, s3, 9472
    v_add_u32 v186, s21, v184
    s_lshl_b32 s3, s3, 5
    v_add_u32 v187, s3, v185
    v_add_u32 v190, s26, v9
    v_mul_u32_u24 v190, 288, v190
    v_lshl_add_u32 v188, v10, 4, v190
    s_lshl_b32 s3, s19, 6
    v_add_u32 v188, s3, v188
    v_add_u32 v189, 4608, v188
TL_NOFS:
    s_waitcnt lgkmcnt(0)
    s_barrier
    ds_read_b128 v[16:19], v184 offset:0
    ds_read_b128 v[52:55], v184 offset:9472
    ds_read_b128 v[20:23], v184 offset:64
    ds_read_b128 v[56:59], v184 offset:9536
    s_waitcnt vmcnt(2)
    v_mfma_f32_16x16x32_bf16 v[96:99], v[210:213], v[198:201], 0
    v_mfma_f32_16x16x32_bf16 v[100:103], v[208:211], v[198:201], 0
    s_waitcnt vmcnt(1)
    v_mfma_f32_16x16x32_bf16 v[104:107], v[210:213], v[202:205], 0
    v_mfma_f32_16x16x32_bf16 v[108:111], v[208:211], v[202:205], 0
    s_sub_u32 s30, s73, 1
    s_waitcnt lgkmcnt(3)
    v_mfma_f32_16x16x32_bf16 v[96:99], a[0:3], v[16:19], v[96:99]
    ds_read_b128 v[24:27], v184 offset:128
    v_mfma_f32_16x16x32_bf16 v[100:103], a[36:39], v[16:19], v[100:103]
    ds_read_b128 v[60:63], v184 offset:9600
    s_waitcnt lgkmcnt(4)
    v_mfma_f32_16x16x32_bf16 v[104:107], a[0:3], v[52:55], v[104:107]
    v_mfma_f32_16x16x32_bf16 v[108:111], a[36:39], v[52:55], v[108:111]
    s_waitcnt lgkmcnt(3)
    v_mfma_f32_16x16x32_bf16 v[96:99], a[4:7], v[20:23], v[96:99]
    ds_read_b128 v[28:31], v184 offset:192
    v_mfma_f32_16x16x32_bf16 v[100:103], a[40:43], v[20:23], v[100:103]
    ds_read_b128 v[64:67], v184 offset:9664
    s_waitcnt lgkmcnt(4)
    v_mfma_f32_16x16x32_bf16 v[104:107], a[4:7], v[56:59], v[104:107]
    v_mfma_f32_16x16x32_bf16 v[108:111], a[40:43], v[56:59], v[108:111]
    s_waitcnt lgkmcnt(3)
    v_mfma_f32_16x16x32_bf16 v[96:99], a[8:11], v[24:27], v[96:99]
    ds_read_b128 v[32:35], v184 offset:256
    v_mfma_f32_16x16x32_bf16 v[100:103], a[44:47], v[24:27], v[100:103]
    ds_read_b128 v[68:71], v184 offset:9728
    s_waitcnt lgkmcnt(4)
    v_mfma_f32_16x16x32_bf16 v[104:107], a[8:11], v[60:63], v[104:107]
    v_mfma_f32_16x16x32_bf16 v[108:111], a[44:47], v[60:63], v[108:111]
    s_waitcnt lgkmcnt(3)
    v_mfma_f32_16x16x32_bf16 v[96:99], a[12:15], v[28:31], v[96:99]
    ds_read_b64_tr_b16 v[36:37], v185 offset:0
    v_mfma_f32_16x16x32_bf16 v[100:103], a[48:51], v[28:31], v[100:103]
    ds_read_b64_tr_b16 v[38:39], v185 offset:288
    s_waitcnt lgkmcnt(4)
    v_mfma_f32_16x16x32_bf16 v[104:107], a[12:15], v[64:67], v[104:107]
    ds_read_b64_tr_b16 v[72:73], v185 offset:32
    v_mfma_f32_16x16x32_bf16 v[108:111], a[48:51], v[64:67], v[108:111]
    ds_read_b64_tr_b16 v[74:75], v185 offset:320
    s_waitcnt lgkmcnt(5)
    v_mfma_f32_16x16x32_bf16 v[96:99], a[16:19], v[32:35], v[96:99]
    ds_read_b64_tr_b16 v[40:41], v185 offset:2304
    v_mfma_f32_16x16x32_bf16 v[100:103], a[52:55], v[32:35], v[100:103]
    ds_read_b64_tr_b16 v[42:43], v185 offset:2592
    s_waitcnt lgkmcnt(6)
    v_mfma_f32_16x16x32_bf16 v[104:107], a[16:19], v[68:71], v[104:107]
    ds_read_b64_tr_b16 v[76:77], v185 offset:2336
    v_mfma_f32_16x16x32_bf16 v[108:111], a[52:55], v[68:71], v[108:111]
    ds_read_b64_tr_b16 v[78:79], v185 offset:2624
    s_waitcnt lgkmcnt(6)
    v_mfma_f32_16x16x32_bf16 v[96:99], a[20:23], v[36:39], v[96:99]
    ds_read_b64_tr_b16 v[44:45], v185 offset:4608
    v_mfma_f32_16x16x32_bf16 v[100:103], a[56:59], v[36:39], v[100:103]
    ds_read_b64_tr_b16 v[46:47], v185 offset:4896
    s_waitcnt lgkmcnt(6)
    v_mfma_f32_16x16x32_bf16 v[104:107], a[20:23], v[72:75], v[104:107]
    ds_read_b64_tr_b16 v[80:81], v185 offset:4640
    v_mfma_f32_16x16x32_bf16 v[108:111], a[56:59], v[72:75], v[108:111]
    ds_read_b64_tr_b16 v[82:83], v185 offset:4928
    s_waitcnt lgkmcnt(6)
    v_mfma_f32_16x16x32_bf16 v[96:99], a[24:27], v[40:43], v[96:99]
    ds_read_b64_tr_b16 v[48:49], v185 offset:6912
    v_mfma_f32_16x16x32_bf16 v[100:103], a[60:63], v[40:43], v[100:103]
    ds_read_b64_tr_b16 v[50:51], v185 offset:7200
    s_waitcnt lgkmcnt(6)
    v_mfma_f32_16x16x32_bf16 v[104:107], a[24:27], v[76:79], v[104:107]
    ds_read_b64_tr_b16 v[84:85], v185 offset:6944
    v_mfma_f32_16x16x32_bf16 v[108:111], a[60:63], v[76:79], v[108:111]
    ds_read_b64_tr_b16 v[86:87], v185 offset:7232
    s_cmp_lt_u32 s30, 2
    s_cbranch_scc1 TL_NOE8
    s_waitcnt vmcnt(0)
    v_mfma_f32_16x16x32_bf16 v[112:115], v[210:213], v[206:209], 0
    ds_read_b128 v[124:127], v186 offset:0
    ds_read_b128 v[128:131], v186 offset:64
    ds_read_b128 v[132:135], v186 offset:128
    ds_read_b128 v[136:139], v186 offset:192
    ds_read_b128 v[140:143], v186 offset:256
    ds_read_b64_tr_b16 v[144:145], v187 offset:0
    ds_read_b64_tr_b16 v[146:147], v187 offset:288
    ds_read_b64_tr_b16 v[148:149], v187 offset:2304
    ds_read_b64_tr_b16 v[150:151], v187 offset:2592
    ds_read_b64_tr_b16 v[152:153], v187 offset:4608
    ds_read_b64_tr_b16 v[154:155], v187 offset:4896
    ds_read_b64_tr_b16 v[156:157], v187 offset:6912
    ds_read_b64_tr_b16 v[158:159], v187 offset:7200
TL_NOE8:
    s_waitcnt lgkmcnt(6)
    v_mfma_f32_16x16x32_bf16 v[96:99], a[28:31], v[44:47], v[96:99]
    v_mfma_f32_16x16x32_bf16 v[100:103], a[64:67], v[44:47], v[100:103]
    s_waitcnt lgkmcnt(4)
    v_mfma_f32_16x16x32_bf16 v[104:107], a[28:31], v[80:83], v[104:107]
    v_mfma_f32_16x16x32_bf16 v[108:111], a[64:67], v[80:83], v[108:111]
    s_waitcnt lgkmcnt(2)
    v_mfma_f32_16x16x32_bf16 v[96:99], a[32:35], v[48:51], v[96:99]
    v_mfma_f32_16x16x32_bf16 v[100:103], a[68:71], v[48:51], v[100:103]
    s_waitcnt lgkmcnt(0)
    v_mfma_f32_16x16x32_bf16 v[104:107], a[32:35], v[84:87], v[104:107]
    v_mfma_f32_16x16x32_bf16 v[108:111], a[68:71], v[84:87], v[108:111]
    s_cmp_lt_u32 s30, 2
    s_cbranch_scc1 TL_FIN
    v_mfma_f32_16x16x32_bf16 v[112:115], a[72:75], v[124:127], v[112:115]
    s_and_b32 s3, s73, 1
    s_mul_i32 s3, s3, 4608
    v_mfma_f32_16x16x32_bf16 v[112:115], a[76:79], v[128:131], v[112:115]
    v_lshl_add_u32 v14, v10, 3, v190
    v_add_u32 v14, s3, v14
    v_mfma_f32_16x16x32_bf16 v[112:115], a[80:83], v[132:135], v[112:115]
    v_cvt_pk_bf16_f32 v16, v96, v97
    v_cvt_pk_bf16_f32 v17, v98, v99
    v_mfma_f32_16x16x32_bf16 v[112:115], a[84:87], v[136:139], v[112:115]
    v_cvt_pk_bf16_f32 v18, v100, v101
    v_cvt_pk_bf16_f32 v19, v102, v103
    v_mfma_f32_16x16x32_bf16 v[112:115], a[88:91], v[140:143], v[112:115]
    buffer_store_dwordx4 v[16:19], v188, s[44:47], s39 offen nt
    v_mfma_f32_16x16x32_bf16 v[112:115], a[92:95], v[144:147], v[112:115]
    v_cvt_pk_bf16_f32 v20, v104, v105
    v_mfma_f32_16x16x32_bf16 v[112:115], a[96:99], v[148:151], v[112:115]
    v_cvt_pk_bf16_f32 v21, v106, v107
    v_mfma_f32_16x16x32_bf16 v[112:115], a[100:103], v[152:155], v[112:115]
    v_cvt_pk_bf16_f32 v22, v108, v109
    v_mfma_f32_16x16x32_bf16 v[112:115], a[104:107], v[156:159], v[112:115]
    v_cvt_pk_bf16_f32 v23, v110, v111
    buffer_store_dwordx4 v[20:23], v189, s[44:47], s39 offen nt
    s_nop 5
    v_cvt_pk_bf16_f32 v120, v112, v113
    v_cvt_pk_bf16_f32 v121, v114, v115
    buffer_store_dwordx2 v[120:121], v14, s[44:47], s39 offen offset:256 nt
    s_branch TL_FINE
TL_FIN:
    s_nop 1
    v_cvt_pk_bf16_f32 v16, v96, v97
    v_cvt_pk_bf16_f32 v17, v98, v99
    v_cvt_pk_bf16_f32 v18, v100, v101
    v_cvt_pk_bf16_f32 v19, v102, v103
    buffer_store_dwordx4 v[16:19], v188, s[44:47], s39 offen nt
    v_cvt_pk_bf16_f32 v20, v104, v105
    v_cvt_pk_bf16_f32 v21, v106, v107
    v_cvt_pk_bf16_f32 v22, v108, v109
    v_cvt_pk_bf16_f32 v23, v110, v111
    buffer_store_dwordx4 v[20:23], v189, s[44:47], s39 offen nt
TL_FINE:
K_END:
    s_endpgm
K_SLOW:
    ds_read_b128 a[12:15], v53 offset:96
    ds_read_b128 a[48:51], v54 offset:96
    ds_read_b128 a[16:19], v53 offset:128
    ds_read_b128 a[52:55], v54 offset:128
    ds_read_b128 a[20:23], v53 offset:160
    ds_read_b128 a[56:59], v54 offset:160
    ds_read_b128 a[24:27], v53 offset:192
    ds_read_b128 a[60:63], v54 offset:192
    ds_read_b128 a[28:31], v53 offset:224
    ds_read_b128 a[64:67], v54 offset:224
    ds_read_b128 a[32:35], v53 offset:256
    ds_read_b128 a[68:71], v54 offset:256
    s_waitcnt vmcnt(0)
    v_add_u32 v12, 0, v0
    v_lshrrev_b32 v14, 1, v12
    s_mov_b32 s3, 125
    v_cmp_gt_u32 s[30:31], s3, v14
    s_lshl_b32 s3, s16, 7
    v_add_u32 v14, s3, v14
    v_lshlrev_b32 v14, 6, v14
    v_and_b32 v12, 1, v12
    v_lshl_add_u32 v14, v12, 2, v14
    v_add_u32 v14, 8388608, v14
    s_mov_b64 exec, s[30:31]
    s_mov_b32 s65, 0
POLL7:
    buffer_load_dword v12, v14, s[8:11], 0 offen sc1
POLLC7:
    s_waitcnt vmcnt(0)
    v_cmp_ne_u32 vcc, s64, v12
    s_add_u32 s65, s65, 1
    s_nop 3
    s_cbranch_vccz POLLD7
    s_sleep 1
    s_cmp_lt_u32 s65, 65536
    s_cbranch_scc1 POLL7
POLLD7:
    s_mov_b64 exec, -1
    v_add_u32 v12, 64, v0
    v_lshrrev_b32 v14, 1, v12
    s_mov_b32 s3, 125
    v_cmp_gt_u32 s[30:31], s3, v14
    s_lshl_b32 s3, s16, 7
    v_add_u32 v14, s3, v14
    v_lshlrev_b32 v14, 6, v14
    v_and_b32 v12, 1, v12
    v_lshl_add_u32 v14, v12, 2, v14
    v_add_u32 v14, 8388608, v14
    s_mov_b64 exec, s[30:31]
    s_mov_b32 s65, 0
POLL8:
    buffer_load_dword v12, v14, s[8:11], 0 offen sc1
POLLC8:
    s_waitcnt vmcnt(0)
    v_cmp_ne_u32 vcc, s64, v12
    s_add_u32 s65, s65, 1
    s_nop 3
    s_cbranch_vccz POLLD8
    s_sleep 1
    s_cmp_lt_u32 s65, 65536
    s_cbranch_scc1 POLL8
POLLD8:
    s_mov_b64 exec, -1
    v_add_u32 v12, 128, v0
    v_lshrrev_b32 v14, 1, v12
    s_mov_b32 s3, 125
    v_cmp_gt_u32 s[30:31], s3, v14
    s_lshl_b32 s3, s16, 7
    v_add_u32 v14, s3, v14
    v_lshlrev_b32 v14, 6, v14
    v_and_b32 v12, 1, v12
    v_lshl_add_u32 v14, v12, 2, v14
    v_add_u32 v14, 8388608, v14
    s_mov_b64 exec, s[30:31]
    s_mov_b32 s65, 0
POLL9:
    buffer_load_dword v12, v14, s[8:11], 0 offen sc1
POLLC9:
    s_waitcnt vmcnt(0)
    v_cmp_ne_u32 vcc, s64, v12
    s_add_u32 s65, s65, 1
    s_nop 3
    s_cbranch_vccz POLLD9
    s_sleep 1
    s_cmp_lt_u32 s65, 65536
    s_cbranch_scc1 POLL9
POLLD9:
    s_mov_b64 exec, -1
    v_add_u32 v12, 192, v0
    v_lshrrev_b32 v14, 1, v12
    s_mov_b32 s3, 125
    v_cmp_gt_u32 s[30:31], s3, v14
    s_lshl_b32 s3, s16, 7
    v_add_u32 v14, s3, v14
    v_lshlrev_b32 v14, 6, v14
    v_and_b32 v12, 1, v12
    v_lshl_add_u32 v14, v12, 2, v14
    v_add_u32 v14, 8388608, v14
    s_mov_b64 exec, s[30:31]
    s_mov_b32 s65, 0
POLL10:
    buffer_load_dword v12, v14, s[8:11], 0 offen sc1
POLLC10:
    s_waitcnt vmcnt(0)
    v_cmp_ne_u32 vcc, s64, v12
    s_add_u32 s65, s65, 1
    s_nop 3
    s_cbranch_vccz POLLD10
    s_sleep 1
    s_cmp_lt_u32 s65, 65536
    s_cbranch_scc1 POLL10
POLLD10:
    s_mov_b64 exec, -1
    s_mul_i32 s13, s19, 10240
    v_add_u32 v8, s13, v4
    v_add_u32 v9, s13, v5
    v_add_u32 v10, s13, v6
    v_add_u32 v11, s13, v7
    v_mov_b32 v14, 0xff800000
    v_mov_b32 v15, 0xff800000
    s_mul_i32 s12, s19, 10240
    s_mov_b32 s20, s19
SL_P1:
    s_mov_b32 m0, s13
    s_nop 0
    buffer_load_dwordx4 v1, s[4:7], s12 offen offset:0 sc1 lds
    buffer_load_dwordx4 v1, s[4:7], s12 offen offset:1024 sc1 lds
    buffer_load_dwordx4 v1, s[4:7], s12 offen offset:2048 sc1 lds
    buffer_load_dwordx4 v1, s[4:7], s12 offen offset:3072 sc1 lds
    s_add_u32 m0, s13, 4096
    s_nop 0
    buffer_load_dwordx4 v2, s[4:7], s12 offen offset:0 sc1 lds
    buffer_load_dwordx4 v2, s[4:7], s12 offen offset:1024 sc1 lds
    buffer_load_dwordx4 v2, s[4:7], s12 offen offset:2048 sc1 lds
    buffer_load_dwordx4 v2, s[4:7], s12 offen offset:3072 sc1 lds
    s_add_u32 m0, s13, 8192
    s_nop 0
    buffer_load_dwordx4 v3, s[4:7], s12 offen offset:0 sc1 lds
    buffer_load_dwordx4 v3, s[4:7], s12 offen offset:1024 sc1 lds
    s_waitcnt vmcnt(0)
    ds_read_b128 a[72:75], v8 offset:0
    ds_read_b128 a[76:79], v9 offset:0
    ds_read_b128 a[80:83], v8 offset:64
    ds_read_b128 a[84:87], v9 offset:64
    ds_read_b128 a[88:91], v8 offset:128
    ds_read_b128 a[92:95], v9 offset:128
    ds_read_b128 a[96:99], v8 offset:192
    ds_read_b128 a[100:103], v9 offset:192
    ds_read_b128 a[104:107], v8 offset:256
    s_waitcnt lgkmcnt(8)
    v_mfma_f32_32x32x16_bf16 v[16:31], a[72:75], a[0:3], 0
    v_mfma_f32_32x32x16_bf16 v[32:47], a[72:75], a[36:39], 0
    s_waitcnt lgkmcnt(7)
    v_mfma_f32_32x32x16_bf16 v[16:31], a[76:79], a[4:7], v[16:31]
    v_mfma_f32_32x32x16_bf16 v[32:47], a[76:79], a[40:43], v[32:47]
    s_waitcnt lgkmcnt(6)
    v_mfma_f32_32x32x16_bf16 v[16:31], a[80:83], a[8:11], v[16:31]
    v_mfma_f32_32x32x16_bf16 v[32:47], a[80:83], a[44:47], v[32:47]
    s_waitcnt lgkmcnt(5)
    v_mfma_f32_32x32x16_bf16 v[16:31], a[84:87], a[12:15], v[16:31]
    v_mfma_f32_32x32x16_bf16 v[32:47], a[84:87], a[48:51], v[32:47]
    s_waitcnt lgkmcnt(4)
    v_mfma_f32_32x32x16_bf16 v[16:31], a[88:91], a[16:19], v[16:31]
    v_mfma_f32_32x32x16_bf16 v[32:47], a[88:91], a[52:55], v[32:47]
    s_waitcnt lgkmcnt(3)
    v_mfma_f32_32x32x16_bf16 v[16:31], a[92:95], a[20:23], v[16:31]
    v_mfma_f32_32x32x16_bf16 v[32:47], a[92:95], a[56:59], v[32:47]
    s_waitcnt lgkmcnt(2)
    v_mfma_f32_32x32x16_bf16 v[16:31], a[96:99], a[24:27], v[16:31]
    v_mfma_f32_32x32x16_bf16 v[32:47], a[96:99], a[60:63], v[32:47]
    s_waitcnt lgkmcnt(1)
    v_mfma_f32_32x32x16_bf16 v[16:31], a[100:103], a[28:31], v[16:31]
    v_mfma_f32_32x32x16_bf16 v[32:47], a[100:103], a[64:67], v[32:47]
    s_waitcnt lgkmcnt(0)
    v_mfma_f32_32x32x16_bf16 v[16:31], a[104:107], a[32:35], v[16:31]
    v_mfma_f32_32x32x16_bf16 v[32:47], a[104:107], a[68:71], v[32:47]
    s_nop 10
    v_max3_f32 v14, v16, v17, v14
    v_max3_f32 v14, v18, v19, v14
    v_max3_f32 v14, v20, v21, v14
    v_max3_f32 v14, v22, v23, v14
    v_max3_f32 v14, v24, v25, v14
    v_max3_f32 v14, v26, v27, v14
    v_max3_f32 v14, v28, v29, v14
    v_max3_f32 v14, v30, v31, v14
    v_max3_f32 v15, v32, v33, v15
    v_max3_f32 v15, v34, v35, v15
    v_max3_f32 v15, v36, v37, v15
    v_max3_f32 v15, v38, v39, v15
    v_max3_f32 v15, v40, v41, v15
    v_max3_f32 v15, v42, v43, v15
    v_max3_f32 v15, v44, v45, v15
    v_max3_f32 v15, v46, v47, v15
    s_add_u32 s12, s12, 40960
    s_add_u32 s20, s20, 4
    s_cmp_lt_u32 s20, 125
    s_cbranch_scc1 SL_P1
    v_mov_b32 v12, v14
    s_nop 1
    v_permlane32_swap_b32 v14, v12
    v_max_f32 v14, v14, v12
    v_mov_b32 v12, v15
    s_nop 1
    v_permlane32_swap_b32 v15, v12
    v_max_f32 v15, v15, v12
    v_and_b32 v12, 15, v0
    v_bfe_u32 v16, v0, 4, 1
    s_add_u32 s3, s19, 1
    v_add_u32 v17, s3, v16
    v_and_b32 v17, 3, v17
    v_lshl_add_u32 v17, v17, 4, v12
    v_lshlrev_b32 v17, 2, v17
    v_add_u32 v18, 148480, v17
    s_add_u32 s3, s3, 2
    v_add_u32 v17, s3, v16
    v_and_b32 v17, 3, v17
    v_lshl_add_u32 v17, v17, 4, v12
    v_lshlrev_b32 v17, 2, v17
    v_add_u32 v19, 148480, v17
    s_lshl_b32 s3, s19, 8
    v_add_u32 v17, s3, v18
    ds_write_b32 v17, v14
    v_add_u32 v17, s3, v19
    ds_write_b32 v17, v15
    s_waitcnt lgkmcnt(0)
    s_barrier
    ds_read_b32 v20, v18 offset:0
    ds_read_b32 v21, v18 offset:256
    ds_read_b32 v22, v18 offset:512
    ds_read_b32 v23, v18 offset:768
    s_waitcnt lgkmcnt(1)
    v_max3_f32 v20, v20, v21, v22
    s_waitcnt lgkmcnt(0)
    v_max_f32 v14, v20, v23
    ds_read_b32 v20, v19 offset:0
    ds_read_b32 v21, v19 offset:256
    ds_read_b32 v22, v19 offset:512
    ds_read_b32 v23, v19 offset:768
    s_waitcnt lgkmcnt(1)
    v_max3_f32 v20, v20, v21, v22
    s_waitcnt lgkmcnt(0)
    v_max_f32 v15, v20, v23
    s_barrier
    s_lshl_b32 s3, s17, 2
    s_add_u32 s3, s3, s19
    s_mul_i32 s12, s3, 163840
    s_mov_b32 s20, 0
SL_P2:
    s_mov_b32 m0, s13
    s_nop 0
    buffer_load_dwordx4 v1, s[4:7], s12 offen offset:0 sc1 lds
    buffer_load_dwordx4 v1, s[4:7], s12 offen offset:1024 sc1 lds
    buffer_load_dwordx4 v1, s[4:7], s12 offen offset:2048 sc1 lds
    buffer_load_dwordx4 v1, s[4:7], s12 offen offset:3072 sc1 lds
    s_add_u32 m0, s13, 4096
    s_nop 0
    buffer_load_dwordx4 v2, s[4:7], s12 offen offset:0 sc1 lds
    buffer_load_dwordx4 v2, s[4:7], s12 offen offset:1024 sc1 lds
    buffer_load_dwordx4 v2, s[4:7], s12 offen offset:2048 sc1 lds
    buffer_load_dwordx4 v2, s[4:7], s12 offen offset:3072 sc1 lds
    s_add_u32 m0, s13, 8192
    s_nop 0
    buffer_load_dwordx4 v3, s[4:7], s12 offen offset:0 sc1 lds
    buffer_load_dwordx4 v3, s[4:7], s12 offen offset:1024 sc1 lds
    s_waitcnt vmcnt(0)
    ds_read_b128 a[72:75], v8 offset:0
    ds_read_b128 a[76:79], v9 offset:0
    ds_read_b128 a[80:83], v8 offset:64
    ds_read_b128 a[84:87], v9 offset:64
    ds_read_b128 a[88:91], v8 offset:128
    ds_read_b128 a[92:95], v9 offset:128
    ds_read_b128 a[96:99], v8 offset:192
    ds_read_b128 a[100:103], v9 offset:192
    ds_read_b128 a[104:107], v8 offset:256
    ds_read_b64_tr_b16 a[108:109], v10 offset:0
    ds_read_b64_tr_b16 a[110:111], v10 offset:5120
    ds_read_b64_tr_b16 a[112:113], v11 offset:0
    ds_read_b64_tr_b16 a[114:115], v11 offset:5120
    ds_read_b64_tr_b16 a[116:117], v10 offset:64
    ds_read_b64_tr_b16 a[118:119], v10 offset:5184
    ds_read_b64_tr_b16 a[120:121], v11 offset:64
    ds_read_b64_tr_b16 a[122:123], v11 offset:5184
    ds_read_b64_tr_b16 a[124:125], v10 offset:128
    ds_read_b64_tr_b16 a[126:127], v10 offset:5248
    ds_read_b64_tr_b16 a[128:129], v11 offset:128
    ds_read_b64_tr_b16 a[130:131], v11 offset:5248
    ds_read_b64_tr_b16 a[132:133], v10 offset:192
    ds_read_b64_tr_b16 a[134:135], v10 offset:5312
    ds_read_b64_tr_b16 a[136:137], v11 offset:192
    ds_read_b64_tr_b16 a[138:139], v11 offset:5312
    ds_read_b64_tr_b16 a[140:141], v10 offset:256
    ds_read_b64_tr_b16 a[142:143], v10 offset:5376
    ds_read_b64_tr_b16 a[144:145], v11 offset:256
    ds_read_b64_tr_b16 a[146:147], v11 offset:5376
    s_waitcnt lgkmcnt(15)
    v_mfma_f32_32x32x16_bf16 v[16:31], a[72:75], a[0:3], 0
    v_mfma_f32_32x32x16_bf16 v[32:47], a[72:75], a[36:39], 0
    v_mfma_f32_32x32x16_bf16 v[16:31], a[76:79], a[4:7], v[16:31]
    v_mfma_f32_32x32x16_bf16 v[32:47], a[76:79], a[40:43], v[32:47]
    v_mfma_f32_32x32x16_bf16 v[16:31], a[80:83], a[8:11], v[16:31]
    v_mfma_f32_32x32x16_bf16 v[32:47], a[80:83], a[44:47], v[32:47]
    v_mfma_f32_32x32x16_bf16 v[16:31], a[84:87], a[12:15], v[16:31]
    v_mfma_f32_32x32x16_bf16 v[32:47], a[84:87], a[48:51], v[32:47]
    v_mfma_f32_32x32x16_bf16 v[16:31], a[88:91], a[16:19], v[16:31]
    v_mfma_f32_32x32x16_bf16 v[32:47], a[88:91], a[52:55], v[32:47]
    v_mfma_f32_32x32x16_bf16 v[16:31], a[92:95], a[20:23], v[16:31]
    v_mfma_f32_32x32x16_bf16 v[32:47], a[92:95], a[56:59], v[32:47]
    v_mfma_f32_32x32x16_bf16 v[16:31], a[96:99], a[24:27], v[16:31]
    v_mfma_f32_32x32x16_bf16 v[32:47], a[96:99], a[60:63], v[32:47]
    v_mfma_f32_32x32x16_bf16 v[16:31], a[100:103], a[28:31], v[16:31]
    v_mfma_f32_32x32x16_bf16 v[32:47], a[100:103], a[64:67], v[32:47]
    v_mfma_f32_32x32x16_bf16 v[16:31], a[104:107], a[32:35], v[16:31]
    v_mfma_f32_32x32x16_bf16 v[32:47], a[104:107], a[68:71], v[32:47]
    s_nop 10
    v_sub_f32 v16, v16, v14
    v_min_f32 v16, 0, v16
    v_exp_f32 v16, v16
    v_sub_f32 v17, v17, v14
    v_min_f32 v17, 0, v17
    v_exp_f32 v17, v17
    v_sub_f32 v20, v20, v14
    v_min_f32 v20, 0, v20
    v_exp_f32 v20, v20
    v_sub_f32 v21, v21, v14
    v_min_f32 v21, 0, v21
    v_exp_f32 v21, v21
    v_cvt_pk_bf16_f32 v80, v16, v17
    v_cvt_pk_bf16_f32 v84, v20, v21
    v_sub_f32 v18, v18, v14
    v_min_f32 v18, 0, v18
    v_exp_f32 v18, v18
    v_sub_f32 v19, v19, v14
    v_min_f32 v19, 0, v19
    v_exp_f32 v19, v19
    v_sub_f32 v22, v22, v14
    v_min_f32 v22, 0, v22
    v_exp_f32 v22, v22
    v_sub_f32 v23, v23, v14
    v_min_f32 v23, 0, v23
    v_exp_f32 v23, v23
    v_cvt_pk_bf16_f32 v81, v18, v19
    v_cvt_pk_bf16_f32 v85, v22, v23
    v_permlane16_swap_b32 v80, v84
    v_sub_f32 v24, v24, v14
    v_min_f32 v24, 0, v24
    v_exp_f32 v24, v24
    v_sub_f32 v25, v25, v14
    v_min_f32 v25, 0, v25
    v_exp_f32 v25, v25
    v_sub_f32 v28, v28, v14
    v_min_f32 v28, 0, v28
    v_exp_f32 v28, v28
    v_sub_f32 v29, v29, v14
    v_min_f32 v29, 0, v29
    v_exp_f32 v29, v29
    v_cvt_pk_bf16_f32 v82, v24, v25
    v_cvt_pk_bf16_f32 v86, v28, v29
    v_permlane16_swap_b32 v81, v85
    v_sub_f32 v26, v26, v14
    v_min_f32 v26, 0, v26
    v_exp_f32 v26, v26
    v_sub_f32 v27, v27, v14
    v_min_f32 v27, 0, v27
    v_exp_f32 v27, v27
    v_sub_f32 v30, v30, v14
    v_min_f32 v30, 0, v30
    v_exp_f32 v30, v30
    v_sub_f32 v31, v31, v14
    v_min_f32 v31, 0, v31
    v_exp_f32 v31, v31
    v_cvt_pk_bf16_f32 v83, v26, v27
    v_cvt_pk_bf16_f32 v87, v30, v31
    v_permlane16_swap_b32 v82, v86
    s_nop 0
    v_permlane16_swap_b32 v83, v87
    v_sub_f32 v32, v32, v15
    v_min_f32 v32, 0, v32
    v_exp_f32 v32, v32
    v_sub_f32 v33, v33, v15
    v_min_f32 v33, 0, v33
    v_exp_f32 v33, v33
    v_sub_f32 v36, v36, v15
    v_min_f32 v36, 0, v36
    v_exp_f32 v36, v36
    v_sub_f32 v37, v37, v15
    v_min_f32 v37, 0, v37
    v_exp_f32 v37, v37
    v_cvt_pk_bf16_f32 v88, v32, v33
    v_cvt_pk_bf16_f32 v92, v36, v37
    v_sub_f32 v34, v34, v15
    v_min_f32 v34, 0, v34
    v_exp_f32 v34, v34
    v_sub_f32 v35, v35, v15
    v_min_f32 v35, 0, v35
    v_exp_f32 v35, v35
    v_sub_f32 v38, v38, v15
    v_min_f32 v38, 0, v38
    v_exp_f32 v38, v38
    v_sub_f32 v39, v39, v15
    v_min_f32 v39, 0, v39
    v_exp_f32 v39, v39
    v_cvt_pk_bf16_f32 v89, v34, v35
    v_cvt_pk_bf16_f32 v93, v38, v39
    v_permlane16_swap_b32 v88, v92
    v_sub_f32 v40, v40, v15
    v_min_f32 v40, 0, v40
    v_exp_f32 v40, v40
    v_sub_f32 v41, v41, v15
    v_min_f32 v41, 0, v41
    v_exp_f32 v41, v41
    v_sub_f32 v44, v44, v15
    v_min_f32 v44, 0, v44
    v_exp_f32 v44, v44
    v_sub_f32 v45, v45, v15
    v_min_f32 v45, 0, v45
    v_exp_f32 v45, v45
    v_cvt_pk_bf16_f32 v90, v40, v41
    v_cvt_pk_bf16_f32 v94, v44, v45
    v_permlane16_swap_b32 v89, v93
    v_sub_f32 v42, v42, v15
    v_min_f32 v42, 0, v42
    v_exp_f32 v42, v42
    v_sub_f32 v43, v43, v15
    v_min_f32 v43, 0, v43
    v_exp_f32 v43, v43
    v_sub_f32 v46, v46, v15
    v_min_f32 v46, 0, v46
    v_exp_f32 v46, v46
    v_sub_f32 v47, v47, v15
    v_min_f32 v47, 0, v47
    v_exp_f32 v47, v47
    v_cvt_pk_bf16_f32 v91, v42, v43
    v_cvt_pk_bf16_f32 v95, v46, v47
    v_permlane16_swap_b32 v90, v94
    s_nop 0
    v_permlane16_swap_b32 v91, v95
    v_mfma_f32_16x16x32_bf16 v[96:99], a[108:111], v[80:83], v[96:99]
    v_mfma_f32_16x16x32_bf16 v[100:103], a[112:115], v[80:83], v[100:103]
    s_waitcnt lgkmcnt(14)
    v_mfma_f32_16x16x32_bf16 v[104:107], a[116:119], v[80:83], v[104:107]
    s_waitcnt lgkmcnt(12)
    v_mfma_f32_16x16x32_bf16 v[108:111], a[120:123], v[80:83], v[108:111]
    s_waitcnt lgkmcnt(10)
    v_mfma_f32_16x16x32_bf16 v[112:115], a[124:127], v[80:83], v[112:115]
    s_waitcnt lgkmcnt(8)
    v_mfma_f32_16x16x32_bf16 v[116:119], a[128:131], v[80:83], v[116:119]
    s_waitcnt lgkmcnt(6)
    v_mfma_f32_16x16x32_bf16 v[120:123], a[132:135], v[80:83], v[120:123]
    s_waitcnt lgkmcnt(4)
    v_mfma_f32_16x16x32_bf16 v[124:127], a[136:139], v[80:83], v[124:127]
    s_waitcnt lgkmcnt(2)
    v_mfma_f32_16x16x32_bf16 v[128:131], a[140:143], v[80:83], v[128:131]
    s_waitcnt lgkmcnt(0)
    v_mfma_f32_16x16x32_bf16 v[132:135], a[144:147], v[80:83], v[132:135]
    v_mfma_f32_16x16x32_bf16 v[136:139], a[108:111], v[84:87], v[136:139]
    v_mfma_f32_16x16x32_bf16 v[140:143], a[112:115], v[84:87], v[140:143]
    v_mfma_f32_16x16x32_bf16 v[144:147], a[116:119], v[84:87], v[144:147]
    v_mfma_f32_16x16x32_bf16 v[148:151], a[120:123], v[84:87], v[148:151]
    v_mfma_f32_16x16x32_bf16 v[152:155], a[124:127], v[84:87], v[152:155]
    v_mfma_f32_16x16x32_bf16 v[156:159], a[128:131], v[84:87], v[156:159]
    v_mfma_f32_16x16x32_bf16 v[160:163], a[132:135], v[84:87], v[160:163]
    v_mfma_f32_16x16x32_bf16 v[164:167], a[136:139], v[84:87], v[164:167]
    v_mfma_f32_16x16x32_bf16 v[168:171], a[140:143], v[84:87], v[168:171]
    v_mfma_f32_16x16x32_bf16 v[172:175], a[144:147], v[84:87], v[172:175]
    v_mfma_f32_16x16x32_bf16 v[176:179], a[108:111], v[88:91], v[176:179]
    v_mfma_f32_16x16x32_bf16 v[180:183], a[112:115], v[88:91], v[180:183]
    v_mfma_f32_16x16x32_bf16 v[184:187], a[116:119], v[88:91], v[184:187]
    v_mfma_f32_16x16x32_bf16 v[188:191], a[120:123], v[88:91], v[188:191]
    v_mfma_f32_16x16x32_bf16 v[192:195], a[124:127], v[88:91], v[192:195]
    v_mfma_f32_16x16x32_bf16 v[196:199], a[128:131], v[88:91], v[196:199]
    v_mfma_f32_16x16x32_bf16 v[200:203], a[132:135], v[88:91], v[200:203]
    v_mfma_f32_16x16x32_bf16 v[204:207], a[136:139], v[88:91], v[204:207]
    v_mfma_f32_16x16x32_bf16 v[208:211], a[140:143], v[88:91], v[208:211]
    v_mfma_f32_16x16x32_bf16 v[212:215], a[144:147], v[88:91], v[212:215]
    v_mfma_f32_16x16x32_bf16 v[216:219], a[108:111], v[92:95], v[216:219]
    v_mfma_f32_16x16x32_bf16 v[220:223], a[112:115], v[92:95], v[220:223]
    v_mfma_f32_16x16x32_bf16 v[224:227], a[116:119], v[92:95], v[224:227]
    v_mfma_f32_16x16x32_bf16 v[228:231], a[120:123], v[92:95], v[228:231]
    v_mfma_f32_16x16x32_bf16 v[232:235], a[124:127], v[92:95], v[232:235]
    v_mfma_f32_16x16x32_bf16 v[236:239], a[128:131], v[92:95], v[236:239]
    v_mfma_f32_16x16x32_bf16 v[240:243], a[132:135], v[92:95], v[240:243]
    v_mfma_f32_16x16x32_bf16 v[244:247], a[136:139], v[92:95], v[244:247]
    v_mfma_f32_16x16x32_bf16 v[248:251], a[140:143], v[92:95], v[248:251]
    v_mfma_f32_16x16x32_bf16 v[252:255], a[144:147], v[92:95], v[252:255]
    s_add_u32 s12, s12, 10240
    s_add_u32 s20, s20, 1
    s_cmp_lt_u32 s20, 16
    s_cbranch_scc1 SL_P2
    s_lshl_b32 s26, s23, 5
    s_sub_u32 s27, s26, 8
    s_mul_i32 s27, s27, 320
    s_mov_b32 s90, 0xffff
    s_mov_b32 s91, 0xffff
    s_mov_b32 s92, 0xffff0000
    s_mov_b32 s93, 0xffff0000
    s_lshl_b32 s3, s17, 2
    s_add_u32 s3, s3, s19
    s_cmp_eq_u32 s3, 7
    s_cselect_b32 s94, 0, 1.0
    s_mov_b32 s95, s94
    s_add_u32 s3, s19, 0
    s_min_u32 s3, s3, 14
    s_lshl_b32 s3, s3, 10
    s_add_u32 s77, s3, 148480
    s_add_u32 s81, s3, s27
    s_add_u32 s3, s19, 4
    s_min_u32 s3, s3, 14
    s_lshl_b32 s3, s3, 10
    s_add_u32 s78, s3, 148480
    s_add_u32 s82, s3, s27
    s_add_u32 s3, s19, 8
    s_min_u32 s3, s3, 14
    s_lshl_b32 s3, s3, 10
    s_add_u32 s79, s3, 148480
    s_add_u32 s83, s3, s27
    s_add_u32 s3, s19, 12
    s_min_u32 s3, s3, 14
    s_lshl_b32 s3, s3, 10
    s_add_u32 s80, s3, 148480
    s_add_u32 s84, s3, s27
    s_lshl_b32 s3, s17, 1
    s_xor_b32 s3, s3, s19
    s_xor_b32 s73, s3, 2
    s_lshl_b32 s3, s73, 1
    s_add_u32 s3, s3, 1
    s_cmp_eq_u32 s73, 0
    s_cselect_b32 s85, 0, s3
    s_mul_i32 s3, s73, 3
    s_sub_u32 s3, s3, 2
    s_cmp_eq_u32 s73, 0
    s_cselect_b32 s86, 0, s3
    s_mul_i32 s3, s86, 5120
    s_add_u32 s76, s3, 2686976
    s_mul_i32 s3, s85, 5120
    s_add_u32 s74, s3, 2733056
    s_cmp_eq_u32 s73, 0
    s_cselect_b32 s75, 2743296, s76
    s_add_u32 s35, s74, 5120
    s_add_u32 s3, s76, 5120
    s_cmp_eq_u32 s73, 0
    s_cselect_b32 s87, s76, s3
    s_add_u32 s88, s76, 10240
    s_cmp_eq_u32 s73, 0
    s_cselect_b32 s88, s87, s88
    s_cmp_eq_u32 s73, 3
    s_cselect_b32 s88, s87, s88
    s_mul_i32 s89, s19, 10240
    s_add_u32 s89, s89, 46080
    s_mul_i32 s36, s19, 18432
    s_add_u32 s36, s36, 2818048
    s_add_u32 s37, s36, 9216
    v_lshlrev_b32 v13, 6, v0
    v_add_u32 v13, 8585216, v13
    v_subrev_u32 v14, 16, v0
    v_lshrrev_b32 v15, 1, v14
    s_sub_u32 s3, s23, 1
    v_add_u32 v15, s3, v15
    s_mov_b32 s3, 125
    v_cmp_gt_u32 s[28:29], s3, v15
    s_lshl_b32 s3, s16, 7
    v_add_u32 v15, s3, v15
    v_lshlrev_b32 v15, 6, v15
    v_and_b32 v14, 1, v14
    v_lshl_add_u32 v15, v14, 2, v15
    v_add_u32 v15, 8388608, v15
    v_cmp_gt_u32 vcc, 16, v0
    s_nop 1
    v_cndmask_b32 v13, v15, v13, vcc
    s_and_b64 s[28:29], s[28:29], 0x3fffff
    s_or_b64 s[28:29], s[28:29], 0xffff
    s_mov_b64 exec, s[28:29]
    s_mov_b32 s65, 0
POLL11:
    buffer_load_dword v12, v13, s[8:11], 0 offen sc1
POLLC11:
    s_waitcnt vmcnt(0)
    v_cmp_ne_u32 vcc, s64, v12
    s_add_u32 s65, s65, 1
    s_nop 3
    s_cbranch_vccz POLLD11
    s_sleep 1
    s_cmp_lt_u32 s65, 65536
    s_cbranch_scc1 POLL11
POLLD11:
    s_mov_b64 exec, -1
    s_mov_b32 m0, s77
    v_add_u32 v14, s81, v1
    buffer_load_dwordx4 v14, s[4:7], 0 offen sc1 lds
    s_mov_b32 m0, s78
    v_add_u32 v15, s82, v1
    buffer_load_dwordx4 v15, s[4:7], 0 offen sc1 lds
    s_mov_b32 m0, s79
    v_add_u32 v14, s83, v1
    buffer_load_dwordx4 v14, s[4:7], 0 offen sc1 lds
    s_mov_b32 m0, s80
    v_add_u32 v15, s84, v1
    buffer_load_dwordx4 v15, s[4:7], 0 offen sc1 lds
    buffer_load_dwordx4 a[188:191], v1, s[8:11], s74 offen offset:0 sc1
    buffer_load_dwordx4 a[192:195], v1, s[8:11], s74 offen offset:1024 sc1
    buffer_load_dwordx4 a[196:199], v1, s[8:11], s74 offen offset:2048 sc1
    buffer_load_dwordx4 a[200:203], v1, s[8:11], s74 offen offset:3072 sc1
    buffer_load_dwordx4 a[204:207], v2, s[8:11], s74 offen sc1
    buffer_load_dwordx4 a[208:211], v1, s[8:11], s35 offen offset:0 sc1
    buffer_load_dwordx4 a[212:215], v1, s[8:11], s35 offen offset:1024 sc1
    buffer_load_dwordx4 a[216:219], v1, s[8:11], s35 offen offset:2048 sc1
    buffer_load_dwordx4 a[220:223], v1, s[8:11], s35 offen offset:3072 sc1
    buffer_load_dwordx4 a[224:227], v2, s[8:11], s35 offen sc1
    buffer_load_dwordx4 a[228:231], v1, s[8:11], s75 offen offset:0 sc1
    buffer_load_dwordx4 a[232:235], v1, s[8:11], s75 offen offset:1024 sc1
    buffer_load_dwordx4 a[236:239], v1, s[8:11], s75 offen offset:2048 sc1
    buffer_load_dwordx4 a[240:243], v1, s[8:11], s75 offen offset:3072 sc1
    buffer_load_dwordx4 a[244:247], v2, s[8:11], s75 offen sc1
    s_add_u32 m0, s89, 0
    s_nop 0
    buffer_load_dwordx4 v1, s[8:11], s87 offen offset:0 sc1 lds
    buffer_load_dwordx4 v1, s[8:11], s87 offen offset:1024 sc1 lds
    buffer_load_dwordx4 v1, s[8:11], s87 offen offset:2048 sc1 lds
    buffer_load_dwordx4 v1, s[8:11], s87 offen offset:3072 sc1 lds
    s_add_u32 m0, s89, 4096
    s_nop 0
    buffer_load_dwordx4 v2, s[8:11], s87 offen sc1 lds
    s_add_u32 m0, s89, 40960
    s_nop 0
    buffer_load_dwordx4 v1, s[8:11], s88 offen offset:0 sc1 lds
    buffer_load_dwordx4 v1, s[8:11], s88 offen offset:1024 sc1 lds
    buffer_load_dwordx4 v1, s[8:11], s88 offen offset:2048 sc1 lds
    buffer_load_dwordx4 v1, s[8:11], s88 offen offset:3072 sc1 lds
    s_add_u32 m0, s89, 45056
    s_nop 0
    buffer_load_dwordx4 v2, s[8:11], s88 offen sc1 lds
    buffer_load_dwordx4 a[0:3], v1, s[8:11], s36 offen offset:0 sc1
    buffer_load_dwordx4 a[4:7], v1, s[8:11], s36 offen offset:1024 sc1
    buffer_load_dwordx4 a[8:11], v1, s[8:11], s36 offen offset:2048 sc1
    buffer_load_dwordx4 a[12:15], v1, s[8:11], s36 offen offset:3072 sc1
    buffer_load_dwordx4 a[16:19], v2, s[8:11], s36 offen offset:0 sc1
    buffer_load_dwordx4 a[20:23], v2, s[8:11], s36 offen offset:1024 sc1
    buffer_load_dwordx4 a[24:27], v2, s[8:11], s36 offen offset:2048 sc1
    buffer_load_dwordx4 a[28:31], v2, s[8:11], s36 offen offset:3072 sc1
    buffer_load_dwordx4 a[32:35], v3, s[8:11], s36 offen offset:0 sc1
    buffer_load_dwordx4 a[36:39], v1, s[8:11], s37 offen offset:0 sc1
    buffer_load_dwordx4 a[40:43], v1, s[8:11], s37 offen offset:1024 sc1
    buffer_load_dwordx4 a[44:47], v1, s[8:11], s37 offen offset:2048 sc1
    s_mul_i32 s3, s19, 10240
    v_add_u32 v12, s3, v1
    v_add_u32 v13, 81920, v12
    v_cvt_pk_bf16_f32 v16, v96, v97
    v_cvt_pk_bf16_f32 v17, v98, v99
    v_cvt_pk_bf16_f32 v18, v100, v101
    v_cvt_pk_bf16_f32 v19, v102, v103
    ds_write_b128 v12, v[16:19] offset:0
    v_cvt_pk_bf16_f32 v20, v104, v105
    v_cvt_pk_bf16_f32 v21, v106, v107
    v_cvt_pk_bf16_f32 v22, v108, v109
    v_cvt_pk_bf16_f32 v23, v110, v111
    ds_write_b128 v12, v[20:23] offset:1024
    v_cvt_pk_bf16_f32 v24, v112, v113
    v_cvt_pk_bf16_f32 v25, v114, v115
    v_cvt_pk_bf16_f32 v26, v116, v117
    v_cvt_pk_bf16_f32 v27, v118, v119
    ds_write_b128 v12, v[24:27] offset:2048
    v_cvt_pk_bf16_f32 v28, v120, v121
    v_cvt_pk_bf16_f32 v29, v122, v123
    v_cvt_pk_bf16_f32 v30, v124, v125
    v_cvt_pk_bf16_f32 v31, v126, v127
    ds_write_b128 v12, v[28:31] offset:3072
    v_cvt_pk_bf16_f32 v32, v128, v129
    v_cvt_pk_bf16_f32 v33, v130, v131
    v_and_b32 v34, 0xffff0000, v132
    v_sub_f32 v133, v132, v34
    v_cvt_pk_bf16_f32 v34, v34, v133
    v_mov_b32 v35, 0
    ds_write_b128 v12, v[32:35] offset:4096
    v_cvt_pk_bf16_f32 v36, v136, v137
    v_cvt_pk_bf16_f32 v37, v138, v139
    v_cvt_pk_bf16_f32 v38, v140, v141
    v_cvt_pk_bf16_f32 v39, v142, v143
    ds_write_b128 v12, v[36:39] offset:40960
    v_cvt_pk_bf16_f32 v40, v144, v145
    v_cvt_pk_bf16_f32 v41, v146, v147
    v_cvt_pk_bf16_f32 v42, v148, v149
    v_cvt_pk_bf16_f32 v43, v150, v151
    ds_write_b128 v12, v[40:43] offset:41984
    v_cvt_pk_bf16_f32 v44, v152, v153
    v_cvt_pk_bf16_f32 v45, v154, v155
    v_cvt_pk_bf16_f32 v46, v156, v157
    v_cvt_pk_bf16_f32 v47, v158, v159
    ds_write_b128 v12, v[44:47] offset:43008
    v_cvt_pk_bf16_f32 v48, v160, v161
    v_cvt_pk_bf16_f32 v49, v162, v163
    v_cvt_pk_bf16_f32 v50, v164, v165
    v_cvt_pk_bf16_f32 v51, v166, v167
    ds_write_b128 v12, v[48:51] offset:44032
    v_cvt_pk_bf16_f32 v52, v168, v169
    v_cvt_pk_bf16_f32 v53, v170, v171
    v_and_b32 v54, 0xffff0000, v172
    v_sub_f32 v173, v172, v54
    v_cvt_pk_bf16_f32 v54, v54, v173
    v_mov_b32 v55, 0
    ds_write_b128 v12, v[52:55] offset:45056
    v_cvt_pk_bf16_f32 v16, v176, v177
    v_cvt_pk_bf16_f32 v17, v178, v179
    v_cvt_pk_bf16_f32 v18, v180, v181
    v_cvt_pk_bf16_f32 v19, v182, v183
    ds_write_b128 v13, v[16:19] offset:0
    v_cvt_pk_bf16_f32 v20, v184, v185
    v_cvt_pk_bf16_f32 v21, v186, v187
    v_cvt_pk_bf16_f32 v22, v188, v189
    v_cvt_pk_bf16_f32 v23, v190, v191
    ds_write_b128 v13, v[20:23] offset:1024
    v_cvt_pk_bf16_f32 v24, v192, v193
    v_cvt_pk_bf16_f32 v25, v194, v195
    v_cvt_pk_bf16_f32 v26, v196, v197
    v_cvt_pk_bf16_f32 v27, v198, v199
    ds_write_b128 v13, v[24:27] offset:2048
    v_cvt_pk_bf16_f32 v28, v200, v201
    v_cvt_pk_bf16_f32 v29, v202, v203
    v_cvt_pk_bf16_f32 v30, v204, v205
    v_cvt_pk_bf16_f32 v31, v206, v207
    ds_write_b128 v13, v[28:31] offset:3072
    v_cvt_pk_bf16_f32 v32, v208, v209
    v_cvt_pk_bf16_f32 v33, v210, v211
    v_and_b32 v34, 0xffff0000, v212
    v_sub_f32 v213, v212, v34
    v_cvt_pk_bf16_f32 v34, v34, v213
    v_mov_b32 v35, 0
    ds_write_b128 v13, v[32:35] offset:4096
    s_branch K_JOIN
K_SPARE:
    s_mov_b32 s10, 33554432
    s_mov_b32 s11, 0x00020000
    s_mov_b32 s54, 256
    s_mov_b32 s55, 0x00020000
    s_lshl_b32 s3, s17, 1
    s_add_u32 s3, s3, s16
    s_lshl_b32 s3, s3, 2
    s_add_u32 s20, s3, s19
    s_cmp_ge_u32 s20, 10
    s_cbranch_scc1 SP_UP
    s_load_dwordx2 s[4:5], s[0:1], 64
    s_load_dwordx2 s[12:13], s[0:1], 32
    s_load_dwordx2 s[24:25], s[0:1], 56
    s_load_dwordx2 s[36:37], s[0:1], 24
    s_cmp_ge_u32 s20, 5
    s_cselect_b32 s21, 1, 0
    s_mul_i32 s3, s21, 5
    s_sub_u32 s22, s20, s3
    v_and_b32 v2, 31, v0
    v_lshrrev_b32 v3, 5, v0
    s_lshl_b32 s3, s22, 5
    v_add_u32 v4, s3, v2
    s_mul_i32 s3, s21, 41472
    v_mul_u32_u24 v5, 2304, v3
    v_lshl_add_u32 v5, v4, 1, v5
    v_add_u32 v5, s3, v5
    v_mov_b32 v6, 0x7fffffff
    v_cmp_gt_u32 vcc, 144, v4
    s_nop 1
    v_cndmask_b32 v5, v6, v5, vcc
    s_mov_b32 s6, 82944
    s_mov_b32 s7, 0x00020000
    s_mov_b32 s28, 0
    s_waitcnt lgkmcnt(0)
    buffer_load_ushort v170, v5, s[4:7], s28 offen offset:0
    buffer_load_ushort v171, v5, s[4:7], s28 offen offset:288
    buffer_load_ushort v172, v5, s[4:7], s28 offen offset:576
    buffer_load_ushort v173, v5, s[4:7], s28 offen offset:864
    buffer_load_ushort v174, v5, s[4:7], s28 offen offset:1152
    buffer_load_ushort v175, v5, s[4:7], s28 offen offset:1440
    buffer_load_ushort v176, v5, s[4:7], s28 offen offset:1728
    buffer_load_ushort v177, v5, s[4:7], s28 offen offset:2016
    s_add_u32 s28, s28, 4608
    buffer_load_ushort v178, v5, s[4:7], s28 offen offset:0
    buffer_load_ushort v179, v5, s[4:7], s28 offen offset:288
    buffer_load_ushort v180, v5, s[4:7], s28 offen offset:576
    buffer_load_ushort v181, v5, s[4:7], s28 offen offset:864
    buffer_load_ushort v182, v5, s[4:7], s28 offen offset:1152
    buffer_load_ushort v183, v5, s[4:7], s28 offen offset:1440
    buffer_load_ushort v184, v5, s[4:7], s28 offen offset:1728
    buffer_load_ushort v185, v5, s[4:7], s28 offen offset:2016
    s_add_u32 s28, s28, 4608
    buffer_load_ushort v186, v5, s[4:7], s28 offen offset:0
    buffer_load_ushort v187, v5, s[4:7], s28 offen offset:288
    buffer_load_ushort v188, v5, s[4:7], s28 offen offset:576
    buffer_load_ushort v189, v5, s[4:7], s28 offen offset:864
    buffer_load_ushort v190, v5, s[4:7], s28 offen offset:1152
    buffer_load_ushort v191, v5, s[4:7], s28 offen offset:1440
    buffer_load_ushort v192, v5, s[4:7], s28 offen offset:1728
    buffer_load_ushort v193, v5, s[4:7], s28 offen offset:2016
    s_add_u32 s28, s28, 4608
    buffer_load_ushort v194, v5, s[4:7], s28 offen offset:0
    buffer_load_ushort v195, v5, s[4:7], s28 offen offset:288
    buffer_load_ushort v196, v5, s[4:7], s28 offen offset:576
    buffer_load_ushort v197, v5, s[4:7], s28 offen offset:864
    buffer_load_ushort v198, v5, s[4:7], s28 offen offset:1152
    buffer_load_ushort v199, v5, s[4:7], s28 offen offset:1440
    buffer_load_ushort v200, v5, s[4:7], s28 offen offset:1728
    buffer_load_ushort v201, v5, s[4:7], s28 offen offset:2016
    s_add_u32 s28, s28, 4608
    buffer_load_ushort v202, v5, s[4:7], s28 offen offset:0
    buffer_load_ushort v203, v5, s[4:7], s28 offen offset:288
    buffer_load_ushort v204, v5, s[4:7], s28 offen offset:576
    buffer_load_ushort v205, v5, s[4:7], s28 offen offset:864
    buffer_load_ushort v206, v5, s[4:7], s28 offen offset:1152
    buffer_load_ushort v207, v5, s[4:7], s28 offen offset:1440
    buffer_load_ushort v208, v5, s[4:7], s28 offen offset:1728
    buffer_load_ushort v209, v5, s[4:7], s28 offen offset:2016
    s_add_u32 s28, s28, 4608
    buffer_load_ushort v210, v5, s[4:7], s28 offen offset:0
    buffer_load_ushort v211, v5, s[4:7], s28 offen offset:288
    buffer_load_ushort v212, v5, s[4:7], s28 offen offset:576
    buffer_load_ushort v213, v5, s[4:7], s28 offen offset:864
    buffer_load_ushort v214, v5, s[4:7], s28 offen offset:1152
    buffer_load_ushort v215, v5, s[4:7], s28 offen offset:1440
    buffer_load_ushort v216, v5, s[4:7], s28 offen offset:1728
    buffer_load_ushort v217, v5, s[4:7], s28 offen offset:2016
    s_add_u32 s28, s28, 4608
    buffer_load_ushort v218, v5, s[4:7], s28 offen offset:0
    buffer_load_ushort v219, v5, s[4:7], s28 offen offset:288
    buffer_load_ushort v220, v5, s[4:7], s28 offen offset:576
    buffer_load_ushort v221, v5, s[4:7], s28 offen offset:864
    buffer_load_ushort v222, v5, s[4:7], s28 offen offset:1152
    buffer_load_ushort v223, v5, s[4:7], s28 offen offset:1440
    buffer_load_ushort v224, v5, s[4:7], s28 offen offset:1728
    buffer_load_ushort v225, v5, s[4:7], s28 offen offset:2016
    s_add_u32 s28, s28, 4608
    buffer_load_ushort v226, v5, s[4:7], s28 offen offset:0
    buffer_load_ushort v227, v5, s[4:7], s28 offen offset:288
    buffer_load_ushort v228, v5, s[4:7], s28 offen offset:576
    buffer_load_ushort v229, v5, s[4:7], s28 offen offset:864
    buffer_load_ushort v230, v5, s[4:7], s28 offen offset:1152
    buffer_load_ushort v231, v5, s[4:7], s28 offen offset:1440
    buffer_load_ushort v232, v5, s[4:7], s28 offen offset:1728
    buffer_load_ushort v233, v5, s[4:7], s28 offen offset:2016
    s_add_u32 s28, s28, 4608
    buffer_load_ushort v234, v5, s[4:7], s28 offen offset:0
    buffer_load_ushort v235, v5, s[4:7], s28 offen offset:288
    buffer_load_ushort v236, v5, s[4:7], s28 offen offset:576
    buffer_load_ushort v237, v5, s[4:7], s28 offen offset:864
    buffer_load_ushort v238, v5, s[4:7], s28 offen offset:1152
    buffer_load_ushort v239, v5, s[4:7], s28 offen offset:1440
    buffer_load_ushort v240, v5, s[4:7], s28 offen offset:1728
    buffer_load_ushort v241, v5, s[4:7], s28 offen offset:2016
    s_add_u32 s28, s28, 4608
    s_waitcnt vmcnt(63)
    v_lshl_or_b32 v16, v171, 16, v170
    v_lshl_or_b32 v17, v173, 16, v172
    v_lshl_or_b32 v18, v175, 16, v174
    v_lshl_or_b32 v19, v177, 16, v176
    s_waitcnt vmcnt(62)
    v_lshl_or_b32 v20, v179, 16, v178
    s_waitcnt vmcnt(60)
    v_lshl_or_b32 v21, v181, 16, v180
    s_waitcnt vmcnt(58)
    v_lshl_or_b32 v22, v183, 16, v182
    s_waitcnt vmcnt(56)
    v_lshl_or_b32 v23, v185, 16, v184
    s_waitcnt vmcnt(54)
    v_lshl_or_b32 v24, v187, 16, v186
    s_waitcnt vmcnt(52)
    v_lshl_or_b32 v25, v189, 16, v188
    s_waitcnt vmcnt(50)
    v_lshl_or_b32 v26, v191, 16, v190
    s_waitcnt vmcnt(48)
    v_lshl_or_b32 v27, v193, 16, v192
    s_waitcnt vmcnt(46)
    v_lshl_or_b32 v28, v195, 16, v194
    s_waitcnt vmcnt(44)
    v_lshl_or_b32 v29, v197, 16, v196
    s_waitcnt vmcnt(42)
    v_lshl_or_b32 v30, v199, 16, v198
    s_waitcnt vmcnt(40)
    v_lshl_or_b32 v31, v201, 16, v200
    s_waitcnt vmcnt(38)
    v_lshl_or_b32 v32, v203, 16, v202
    s_waitcnt vmcnt(36)
    v_lshl_or_b32 v33, v205, 16, v204
    s_waitcnt vmcnt(34)
    v_lshl_or_b32 v34, v207, 16, v206
    s_waitcnt vmcnt(32)
    v_lshl_or_b32 v35, v209, 16, v208
    s_waitcnt vmcnt(30)
    v_lshl_or_b32 v36, v211, 16, v210
    s_waitcnt vmcnt(28)
    v_lshl_or_b32 v37, v213, 16, v212
    s_waitcnt vmcnt(26)
    v_lshl_or_b32 v38, v215, 16, v214
    s_waitcnt vmcnt(24)
    v_lshl_or_b32 v39, v217, 16, v216
    s_waitcnt vmcnt(22)
    v_lshl_or_b32 v40, v219, 16, v218
    s_waitcnt vmcnt(20)
    v_lshl_or_b32 v41, v221, 16, v220
    s_waitcnt vmcnt(18)
    v_lshl_or_b32 v42, v223, 16, v222
    s_waitcnt vmcnt(16)
    v_lshl_or_b32 v43, v225, 16, v224
    s_waitcnt vmcnt(14)
    v_lshl_or_b32 v44, v227, 16, v226
    s_waitcnt vmcnt(12)
    v_lshl_or_b32 v45, v229, 16, v228
    s_waitcnt vmcnt(10)
    v_lshl_or_b32 v46, v231, 16, v230
    s_waitcnt vmcnt(8)
    v_lshl_or_b32 v47, v233, 16, v232
    s_waitcnt vmcnt(6)
    v_lshl_or_b32 v48, v235, 16, v234
    s_waitcnt vmcnt(4)
    v_lshl_or_b32 v49, v237, 16, v236
    s_waitcnt vmcnt(2)
    v_lshl_or_b32 v50, v239, 16, v238
    s_waitcnt vmcnt(0)
    v_lshl_or_b32 v51, v241, 16, v240
    s_cmp_eq_u32 s21, 1
    s_cselect_b32 s12, s24, s12
    s_cselect_b32 s13, s25, s13
    s_mov_b32 s14, 41472
    s_mov_b32 s15, 0x00020000
    s_mov_b32 s38, 41472
    s_mov_b32 s39, 0x00020000
    v_and_b32 v7, 0x13, v0
    v_and_b32 v8, 4, v0
    v_lshl_or_b32 v7, v8, 1, v7
    v_and_b32 v8, 8, v0
    v_lshrrev_b32 v8, 1, v8
    v_or_b32 v7, v7, v8
    v_mul_u32_u24 v7, 288, v7
    v_lshl_add_u32 v7, v3, 4, v7
    v_lshrrev_b32 v8, 5, v4
    v_lshlrev_b32 v8, 1, v8
    v_bfe_u32 v9, v4, 2, 1
    v_add_u32 v8, v8, v9
    v_bfe_u32 v9, v4, 3, 2
    v_lshlrev_b32 v9, 2, v9
    v_and_b32 v10, 3, v4
    v_add_u32 v9, v9, v10
    s_mov_b32 s30, 128
    v_cmp_gt_u32 s[66:67], s30, v4
    v_and_b32 v10, 15, v4
    s_nop 0
    v_cndmask_b32 v8, 8, v8, s[66:67]
    v_cndmask_b32 v9, v10, v9, s[66:67]
    v_mul_u32_u24 v8, 9216, v8
    v_lshl_add_u32 v8, v9, 4, v8
    v_lshl_add_u32 v8, v3, 8, v8
    v_add_u32 v8, 2818048, v8
    v_cndmask_b32 v8, v6, v8, vcc
    s_mov_b32 s28, 0
    buffer_load_dwordx4 v[100:103], v7, s[12:15], s28 offen offset:0
    buffer_load_dwordx4 v[104:107], v7, s[12:15], s28 offen offset:32
    buffer_load_dwordx4 v[108:111], v7, s[12:15], s28 offen offset:64
    buffer_load_dwordx4 v[112:115], v7, s[12:15], s28 offen offset:96
    buffer_load_dwordx4 v[116:119], v7, s[12:15], s28 offen offset:128
    buffer_load_dwordx4 v[120:123], v7, s[12:15], s28 offen offset:160
    buffer_load_dwordx4 v[124:127], v7, s[12:15], s28 offen offset:192
    buffer_load_dwordx4 v[128:131], v7, s[12:15], s28 offen offset:224
    buffer_load_dwordx4 v[132:135], v7, s[12:15], s28 offen offset:256
    s_mov_b32 s28, 9216
    buffer_load_dwordx4 v[204:207], v7, s[12:15], s28 offen offset:0
    buffer_load_dwordx4 v[208:211], v7, s[12:15], s28 offen offset:32
    buffer_load_dwordx4 v[212:215], v7, s[12:15], s28 offen offset:64
    buffer_load_dwordx4 v[216:219], v7, s[12:15], s28 offen offset:96
    buffer_load_dwordx4 v[220:223], v7, s[12:15], s28 offen offset:128
    buffer_load_dwordx4 v[224:227], v7, s[12:15], s28 offen offset:160
    buffer_load_dwordx4 v[228:231], v7, s[12:15], s28 offen offset:192
    buffer_load_dwordx4 v[232:235], v7, s[12:15], s28 offen offset:224
    buffer_load_dwordx4 v[236:239], v7, s[12:15], s28 offen offset:256
    s_waitcnt vmcnt(17)
    v_mfma_f32_32x32x16_bf16 v[140:155], v[100:103], v[16:19], 0
    s_waitcnt vmcnt(16)
    v_mfma_f32_32x32x16_bf16 v[140:155], v[104:107], v[20:23], v[140:155]
    s_waitcnt vmcnt(15)
    v_mfma_f32_32x32x16_bf16 v[140:155], v[108:111], v[24:27], v[140:155]
    s_waitcnt vmcnt(14)
    v_mfma_f32_32x32x16_bf16 v[140:155], v[112:115], v[28:31], v[140:155]
    s_waitcnt vmcnt(13)
    v_mfma_f32_32x32x16_bf16 v[140:155], v[116:119], v[32:35], v[140:155]
    s_waitcnt vmcnt(12)
    v_mfma_f32_32x32x16_bf16 v[140:155], v[120:123], v[36:39], v[140:155]
    s_waitcnt vmcnt(11)
    v_mfma_f32_32x32x16_bf16 v[140:155], v[124:127], v[40:43], v[140:155]
    s_waitcnt vmcnt(10)
    v_mfma_f32_32x32x16_bf16 v[140:155], v[128:131], v[44:47], v[140:155]
    s_waitcnt vmcnt(9)
    v_mfma_f32_32x32x16_bf16 v[140:155], v[132:135], v[48:51], v[140:155]
    s_nop 11
    v_cvt_pk_bf16_f32 v52, v140, v141
    v_cvt_pk_bf16_f32 v53, v142, v143
    v_cvt_pk_bf16_f32 v54, v144, v145
    v_cvt_pk_bf16_f32 v55, v146, v147
    v_cvt_pk_bf16_f32 v56, v148, v149
    v_cvt_pk_bf16_f32 v57, v150, v151
    v_cvt_pk_bf16_f32 v58, v152, v153
    v_cvt_pk_bf16_f32 v59, v154, v155
    s_mov_b32 s28, 18432
    buffer_load_dwordx4 v[100:103], v7, s[12:15], s28 offen offset:0
    buffer_load_dwordx4 v[104:107], v7, s[12:15], s28 offen offset:32
    buffer_load_dwordx4 v[108:111], v7, s[12:15], s28 offen offset:64
    buffer_load_dwordx4 v[112:115], v7, s[12:15], s28 offen offset:96
    buffer_load_dwordx4 v[116:119], v7, s[12:15], s28 offen offset:128
    buffer_load_dwordx4 v[120:123], v7, s[12:15], s28 offen offset:160
    buffer_load_dwordx4 v[124:127], v7, s[12:15], s28 offen offset:192
    buffer_load_dwordx4 v[128:131], v7, s[12:15], s28 offen offset:224
    buffer_load_dwordx4 v[132:135], v7, s[12:15], s28 offen offset:256
    s_waitcnt vmcnt(17)
    v_mfma_f32_32x32x16_bf16 v[140:155], v[204:207], v[16:19], 0
    s_waitcnt vmcnt(16)
    v_mfma_f32_32x32x16_bf16 v[140:155], v[208:211], v[20:23], v[140:155]
    s_waitcnt vmcnt(15)
    v_mfma_f32_32x32x16_bf16 v[140:155], v[212:215], v[24:27], v[140:155]
    s_waitcnt vmcnt(14)
    v_mfma_f32_32x32x16_bf16 v[140:155], v[216:219], v[28:31], v[140:155]
    s_waitcnt vmcnt(13)
    v_mfma_f32_32x32x16_bf16 v[140:155], v[220:223], v[32:35], v[140:155]
    s_waitcnt vmcnt(12)
    v_mfma_f32_32x32x16_bf16 v[140:155], v[224:227], v[36:39], v[140:155]
    s_waitcnt vmcnt(11)
    v_mfma_f32_32x32x16_bf16 v[140:155], v[228:231], v[40:43], v[140:155]
    s_waitcnt vmcnt(10)
    v_mfma_f32_32x32x16_bf16 v[140:155], v[232:235], v[44:47], v[140:155]
    s_waitcnt vmcnt(9)
    v_mfma_f32_32x32x16_bf16 v[140:155], v[236:239], v[48:51], v[140:155]
    s_nop 11
    v_cvt_pk_bf16_f32 v60, v140, v141
    v_cvt_pk_bf16_f32 v61, v142, v143
    v_cvt_pk_bf16_f32 v62, v144, v145
    v_cvt_pk_bf16_f32 v63, v146, v147
    v_cvt_pk_bf16_f32 v64, v148, v149
    v_cvt_pk_bf16_f32 v65, v150, v151
    v_cvt_pk_bf16_f32 v66, v152, v153
    v_cvt_pk_bf16_f32 v67, v154, v155
    s_mov_b32 s28, 27648
    buffer_load_dwordx4 v[204:207], v7, s[12:15], s28 offen offset:0
    buffer_load_dwordx4 v[208:211], v7, s[12:15], s28 offen offset:32
    buffer_load_dwordx4 v[212:215], v7, s[12:15], s28 offen offset:64
    buffer_load_dwordx4 v[216:219], v7, s[12:15], s28 offen offset:96
    buffer_load_dwordx4 v[220:223], v7, s[12:15], s28 offen offset:128
    buffer_load_dwordx4 v[224:227], v7, s[12:15], s28 offen offset:160
    buffer_load_dwordx4 v[228:231], v7, s[12:15], s28 offen offset:192
    buffer_load_dwordx4 v[232:235], v7, s[12:15], s28 offen offset:224
    buffer_load_dwordx4 v[236:239], v7, s[12:15], s28 offen offset:256
    s_waitcnt vmcnt(17)
    v_mfma_f32_32x32x16_bf16 v[140:155], v[100:103], v[16:19], 0
    s_waitcnt vmcnt(16)
    v_mfma_f32_32x32x16_bf16 v[140:155], v[104:107], v[20:23], v[140:155]
    s_waitcnt vmcnt(15)
    v_mfma_f32_32x32x16_bf16 v[140:155], v[108:111], v[24:27], v[140:155]
    s_waitcnt vmcnt(14)
    v_mfma_f32_32x32x16_bf16 v[140:155], v[112:115], v[28:31], v[140:155]
    s_waitcnt vmcnt(13)
    v_mfma_f32_32x32x16_bf16 v[140:155], v[116:119], v[32:35], v[140:155]
    s_waitcnt vmcnt(12)
    v_mfma_f32_32x32x16_bf16 v[140:155], v[120:123], v[36:39], v[140:155]
    s_waitcnt vmcnt(11)
    v_mfma_f32_32x32x16_bf16 v[140:155], v[124:127], v[40:43], v[140:155]
    s_waitcnt vmcnt(10)
    v_mfma_f32_32x32x16_bf16 v[140:155], v[128:131], v[44:47], v[140:155]
    s_waitcnt vmcnt(9)
    v_mfma_f32_32x32x16_bf16 v[140:155], v[132:135], v[48:51], v[140:155]
    s_nop 11
    v_cvt_pk_bf16_f32 v68, v140, v141
    v_cvt_pk_bf16_f32 v69, v142, v143
    v_cvt_pk_bf16_f32 v70, v144, v145
    v_cvt_pk_bf16_f32 v71, v146, v147
    v_cvt_pk_bf16_f32 v72, v148, v149
    v_cvt_pk_bf16_f32 v73, v150, v151
    v_cvt_pk_bf16_f32 v74, v152, v153
    v_cvt_pk_bf16_f32 v75, v154, v155
    s_mov_b32 s28, 36864
    buffer_load_dwordx4 v[100:103], v7, s[12:15], s28 offen offset:0
    buffer_load_dwordx4 v[104:107], v7, s[12:15], s28 offen offset:32
    buffer_load_dwordx4 v[108:111], v7, s[12:15], s28 offen offset:64
    buffer_load_dwordx4 v[112:115], v7, s[12:15], s28 offen offset:96
    buffer_load_dwordx4 v[116:119], v7, s[12:15], s28 offen offset:128
    buffer_load_dwordx4 v[120:123], v7, s[12:15], s28 offen offset:160
    buffer_load_dwordx4 v[124:127], v7, s[12:15], s28 offen offset:192
    buffer_load_dwordx4 v[128:131], v7, s[12:15], s28 offen offset:224
    buffer_load_dwordx4 v[132:135], v7, s[12:15], s28 offen offset:256
    s_waitcnt vmcnt(17)
    v_mfma_f32_32x32x16_bf16 v[140:155], v[204:207], v[16:19], 0
    s_waitcnt vmcnt(16)
    v_mfma_f32_32x32x16_bf16 v[140:155], v[208:211], v[20:23], v[140:155]
    s_waitcnt vmcnt(15)
    v_mfma_f32_32x32x16_bf16 v[140:155], v[212:215], v[24:27], v[140:155]
    s_waitcnt vmcnt(14)
    v_mfma_f32_32x32x16_bf16 v[140:155], v[216:219], v[28:31], v[140:155]
    s_waitcnt vmcnt(13)
    v_mfma_f32_32x32x16_bf16 v[140:155], v[220:223], v[32:35], v[140:155]
    s_waitcnt vmcnt(12)
    v_mfma_f32_32x32x16_bf16 v[140:155], v[224:227], v[36:39], v[140:155]
    s_waitcnt vmcnt(11)
    v_mfma_f32_32x32x16_bf16 v[140:155], v[228:231], v[40:43], v[140:155]
    s_waitcnt vmcnt(10)
    v_mfma_f32_32x32x16_bf16 v[140:155], v[232:235], v[44:47], v[140:155]
    s_waitcnt vmcnt(9)
    v_mfma_f32_32x32x16_bf16 v[140:155], v[236:239], v[48:51], v[140:155]
    s_nop 11
    v_cvt_pk_bf16_f32 v76, v140, v141
    v_cvt_pk_bf16_f32 v77, v142, v143
    v_cvt_pk_bf16_f32 v78, v144, v145
    v_cvt_pk_bf16_f32 v79, v146, v147
    v_cvt_pk_bf16_f32 v80, v148, v149
    v_cvt_pk_bf16_f32 v81, v150, v151
    v_cvt_pk_bf16_f32 v82, v152, v153
    v_cvt_pk_bf16_f32 v83, v154, v155
    s_waitcnt vmcnt(8)
    v_mfma_f32_32x32x16_bf16 v[140:155], v[100:103], v[16:19], 0
    s_waitcnt vmcnt(7)
    v_mfma_f32_32x32x16_bf16 v[140:155], v[104:107], v[20:23], v[140:155]
    s_waitcnt vmcnt(6)
    v_mfma_f32_32x32x16_bf16 v[140:155], v[108:111], v[24:27], v[140:155]
    s_waitcnt vmcnt(5)
    v_mfma_f32_32x32x16_bf16 v[140:155], v[112:115], v[28:31], v[140:155]
    s_waitcnt vmcnt(4)
    v_mfma_f32_32x32x16_bf16 v[140:155], v[116:119], v[32:35], v[140:155]
    s_waitcnt vmcnt(3)
    v_mfma_f32_32x32x16_bf16 v[140:155], v[120:123], v[36:39], v[140:155]
    s_waitcnt vmcnt(2)
    v_mfma_f32_32x32x16_bf16 v[140:155], v[124:127], v[40:43], v[140:155]
    s_waitcnt vmcnt(1)
    v_mfma_f32_32x32x16_bf16 v[140:155], v[128:131], v[44:47], v[140:155]
    s_waitcnt vmcnt(0)
    v_mfma_f32_32x32x16_bf16 v[140:155], v[132:135], v[48:51], v[140:155]
    s_nop 11
    v_cvt_pk_bf16_f32 v84, v140, v141
    v_cvt_pk_bf16_f32 v85, v142, v143
    v_cvt_pk_bf16_f32 v86, v144, v145
    v_cvt_pk_bf16_f32 v87, v146, v147
    s_cmp_eq_u32 s21, 1
    s_cbranch_scc1 SP_STC
    s_mov_b32 s28, 0
    buffer_load_dwordx4 v[204:207], v7, s[36:39], s28 offen offset:0
    buffer_load_dwordx4 v[208:211], v7, s[36:39], s28 offen offset:32
    buffer_load_dwordx4 v[212:215], v7, s[36:39], s28 offen offset:64
    buffer_load_dwordx4 v[216:219], v7, s[36:39], s28 offen offset:96
    buffer_load_dwordx4 v[220:223], v7, s[36:39], s28 offen offset:128
    buffer_load_dwordx4 v[224:227], v7, s[36:39], s28 offen offset:160
    buffer_load_dwordx4 v[228:231], v7, s[36:39], s28 offen offset:192
    buffer_load_dwordx4 v[232:235], v7, s[36:39], s28 offen offset:224
    buffer_load_dwordx4 v[236:239], v7, s[36:39], s28 offen offset:256
    s_mov_b32 s28, 9216
    buffer_load_dwordx4 v[100:103], v7, s[36:39], s28 offen offset:0
    buffer_load_dwordx4 v[104:107], v7, s[36:39], s28 offen offset:32
    buffer_load_dwordx4 v[108:111], v7, s[36:39], s28 offen offset:64
    buffer_load_dwordx4 v[112:115], v7, s[36:39], s28 offen offset:96
    buffer_load_dwordx4 v[116:119], v7, s[36:39], s28 offen offset:128
    buffer_load_dwordx4 v[120:123], v7, s[36:39], s28 offen offset:160
    buffer_load_dwordx4 v[124:127], v7, s[36:39], s28 offen offset:192
    buffer_load_dwordx4 v[128:131], v7, s[36:39], s28 offen offset:224
    buffer_load_dwordx4 v[132:135], v7, s[36:39], s28 offen offset:256
    s_waitcnt vmcnt(17)
    v_mfma_f32_32x32x16_bf16 v[140:155], v[204:207], v[52:55], 0
    s_waitcnt vmcnt(16)
    v_mfma_f32_32x32x16_bf16 v[140:155], v[208:211], v[56:59], v[140:155]
    s_waitcnt vmcnt(15)
    v_mfma_f32_32x32x16_bf16 v[140:155], v[212:215], v[60:63], v[140:155]
    s_waitcnt vmcnt(14)
    v_mfma_f32_32x32x16_bf16 v[140:155], v[216:219], v[64:67], v[140:155]
    s_waitcnt vmcnt(13)
    v_mfma_f32_32x32x16_bf16 v[140:155], v[220:223], v[68:71], v[140:155]
    s_waitcnt vmcnt(12)
    v_mfma_f32_32x32x16_bf16 v[140:155], v[224:227], v[72:75], v[140:155]
    s_waitcnt vmcnt(11)
    v_mfma_f32_32x32x16_bf16 v[140:155], v[228:231], v[76:79], v[140:155]
    s_waitcnt vmcnt(10)
    v_mfma_f32_32x32x16_bf16 v[140:155], v[232:235], v[80:83], v[140:155]
    s_waitcnt vmcnt(9)
    v_mfma_f32_32x32x16_bf16 v[140:155], v[236:239], v[84:87], v[140:155]
    s_nop 11
    v_cvt_pk_bf16_f32 v160, v140, v141
    v_cvt_pk_bf16_f32 v161, v142, v143
    v_cvt_pk_bf16_f32 v162, v144, v145
    v_cvt_pk_bf16_f32 v163, v146, v147
    v_cvt_pk_bf16_f32 v164, v148, v149
    v_cvt_pk_bf16_f32 v165, v150, v151
    v_cvt_pk_bf16_f32 v166, v152, v153
    v_cvt_pk_bf16_f32 v167, v154, v155
    s_mov_b32 s29, 0
    buffer_store_dwordx4 v[160:163], v8, s[8:11], s29 offen sc1
    buffer_store_dwordx4 v[164:167], v8, s[8:11], s29 offen offset:512 sc1
    s_mov_b32 s28, 18432
    buffer_load_dwordx4 v[204:207], v7, s[36:39], s28 offen offset:0
    buffer_load_dwordx4 v[208:211], v7, s[36:39], s28 offen offset:32
    buffer_load_dwordx4 v[212:215], v7, s[36:39], s28 offen offset:64
    buffer_load_dwordx4 v[216:219], v7, s[36:39], s28 offen offset:96
    buffer_load_dwordx4 v[220:223], v7, s[36:39], s28 offen offset:128
    buffer_load_dwordx4 v[224:227], v7, s[36:39], s28 offen offset:160
    buffer_load_dwordx4 v[228:231], v7, s[36:39], s28 offen offset:192
    buffer_load_dwordx4 v[232:235], v7, s[36:39], s28 offen offset:224
    buffer_load_dwordx4 v[236:239], v7, s[36:39], s28 offen offset:256
    s_waitcnt vmcnt(19)
    v_mfma_f32_32x32x16_bf16 v[140:155], v[100:103], v[52:55], 0
    s_waitcnt vmcnt(18)
    v_mfma_f32_32x32x16_bf16 v[140:155], v[104:107], v[56:59], v[140:155]
    s_waitcnt vmcnt(17)
    v_mfma_f32_32x32x16_bf16 v[140:155], v[108:111], v[60:63], v[140:155]
    s_waitcnt vmcnt(16)
    v_mfma_f32_32x32x16_bf16 v[140:155], v[112:115], v[64:67], v[140:155]
    s_waitcnt vmcnt(15)
    v_mfma_f32_32x32x16_bf16 v[140:155], v[116:119], v[68:71], v[140:155]
    s_waitcnt vmcnt(14)
    v_mfma_f32_32x32x16_bf16 v[140:155], v[120:123], v[72:75], v[140:155]
    s_waitcnt vmcnt(13)
    v_mfma_f32_32x32x16_bf16 v[140:155], v[124:127], v[76:79], v[140:155]
    s_waitcnt vmcnt(12)
    v_mfma_f32_32x32x16_bf16 v[140:155], v[128:131], v[80:83], v[140:155]
    s_waitcnt vmcnt(11)
    v_mfma_f32_32x32x16_bf16 v[140:155], v[132:135], v[84:87], v[140:155]
    s_nop 11
    v_cvt_pk_bf16_f32 v160, v140, v141
    v_cvt_pk_bf16_f32 v161, v142, v143
    v_cvt_pk_bf16_f32 v162, v144, v145
    v_cvt_pk_bf16_f32 v163, v146, v147
    v_cvt_pk_bf16_f32 v164, v148, v149
    v_cvt_pk_bf16_f32 v165, v150, v151
    v_cvt_pk_bf16_f32 v166, v152, v153
    v_cvt_pk_bf16_f32 v167, v154, v155
    s_mov_b32 s29, 1024
    buffer_store_dwordx4 v[160:163], v8, s[8:11], s29 offen sc1
    buffer_store_dwordx4 v[164:167], v8, s[8:11], s29 offen offset:512 sc1
    s_mov_b32 s28, 27648
    buffer_load_dwordx4 v[100:103], v7, s[36:39], s28 offen offset:0
    buffer_load_dwordx4 v[104:107], v7, s[36:39], s28 offen offset:32
    buffer_load_dwordx4 v[108:111], v7, s[36:39], s28 offen offset:64
    buffer_load_dwordx4 v[112:115], v7, s[36:39], s28 offen offset:96
    buffer_load_dwordx4 v[116:119], v7, s[36:39], s28 offen offset:128
    buffer_load_dwordx4 v[120:123], v7, s[36:39], s28 offen offset:160
    buffer_load_dwordx4 v[124:127], v7, s[36:39], s28 offen offset:192
    buffer_load_dwordx4 v[128:131], v7, s[36:39], s28 offen offset:224
    buffer_load_dwordx4 v[132:135], v7, s[36:39], s28 offen offset:256
    s_waitcnt vmcnt(19)
    v_mfma_f32_32x32x16_bf16 v[140:155], v[204:207], v[52:55], 0
    s_waitcnt vmcnt(18)
    v_mfma_f32_32x32x16_bf16 v[140:155], v[208:211], v[56:59], v[140:155]
    s_waitcnt vmcnt(17)
    v_mfma_f32_32x32x16_bf16 v[140:155], v[212:215], v[60:63], v[140:155]
    s_waitcnt vmcnt(16)
    v_mfma_f32_32x32x16_bf16 v[140:155], v[216:219], v[64:67], v[140:155]
    s_waitcnt vmcnt(15)
    v_mfma_f32_32x32x16_bf16 v[140:155], v[220:223], v[68:71], v[140:155]
    s_waitcnt vmcnt(14)
    v_mfma_f32_32x32x16_bf16 v[140:155], v[224:227], v[72:75], v[140:155]
    s_waitcnt vmcnt(13)
    v_mfma_f32_32x32x16_bf16 v[140:155], v[228:231], v[76:79], v[140:155]
    s_waitcnt vmcnt(12)
    v_mfma_f32_32x32x16_bf16 v[140:155], v[232:235], v[80:83], v[140:155]
    s_waitcnt vmcnt(11)
    v_mfma_f32_32x32x16_bf16 v[140:155], v[236:239], v[84:87], v[140:155]
    s_nop 11
    v_cvt_pk_bf16_f32 v160, v140, v141
    v_cvt_pk_bf16_f32 v161, v142, v143
    v_cvt_pk_bf16_f32 v162, v144, v145
    v_cvt_pk_bf16_f32 v163, v146, v147
    v_cvt_pk_bf16_f32 v164, v148, v149
    v_cvt_pk_bf16_f32 v165, v150, v151
    v_cvt_pk_bf16_f32 v166, v152, v153
    v_cvt_pk_bf16_f32 v167, v154, v155
    s_mov_b32 s29, 2048
    buffer_store_dwordx4 v[160:163], v8, s[8:11], s29 offen sc1
    buffer_store_dwordx4 v[164:167], v8, s[8:11], s29 offen offset:512 sc1
    s_mov_b32 s28, 36864
    buffer_load_dwordx4 v[204:207], v7, s[36:39], s28 offen offset:0
    buffer_load_dwordx4 v[208:211], v7, s[36:39], s28 offen offset:32
    buffer_load_dwordx4 v[212:215], v7, s[36:39], s28 offen offset:64
    buffer_load_dwordx4 v[216:219], v7, s[36:39], s28 offen offset:96
    buffer_load_dwordx4 v[220:223], v7, s[36:39], s28 offen offset:128
    buffer_load_dwordx4 v[224:227], v7, s[36:39], s28 offen offset:160
    buffer_load_dwordx4 v[228:231], v7, s[36:39], s28 offen offset:192
    buffer_load_dwordx4 v[232:235], v7, s[36:39], s28 offen offset:224
    buffer_load_dwordx4 v[236:239], v7, s[36:39], s28 offen offset:256
    s_waitcnt vmcnt(19)
    v_mfma_f32_32x32x16_bf16 v[140:155], v[100:103], v[52:55], 0
    s_waitcnt vmcnt(18)
    v_mfma_f32_32x32x16_bf16 v[140:155], v[104:107], v[56:59], v[140:155]
    s_waitcnt vmcnt(17)
    v_mfma_f32_32x32x16_bf16 v[140:155], v[108:111], v[60:63], v[140:155]
    s_waitcnt vmcnt(16)
    v_mfma_f32_32x32x16_bf16 v[140:155], v[112:115], v[64:67], v[140:155]
    s_waitcnt vmcnt(15)
    v_mfma_f32_32x32x16_bf16 v[140:155], v[116:119], v[68:71], v[140:155]
    s_waitcnt vmcnt(14)
    v_mfma_f32_32x32x16_bf16 v[140:155], v[120:123], v[72:75], v[140:155]
    s_waitcnt vmcnt(13)
    v_mfma_f32_32x32x16_bf16 v[140:155], v[124:127], v[76:79], v[140:155]
    s_waitcnt vmcnt(12)
    v_mfma_f32_32x32x16_bf16 v[140:155], v[128:131], v[80:83], v[140:155]
    s_waitcnt vmcnt(11)
    v_mfma_f32_32x32x16_bf16 v[140:155], v[132:135], v[84:87], v[140:155]
    s_nop 11
    v_cvt_pk_bf16_f32 v160, v140, v141
    v_cvt_pk_bf16_f32 v161, v142, v143
    v_cvt_pk_bf16_f32 v162, v144, v145
    v_cvt_pk_bf16_f32 v163, v146, v147
    v_cvt_pk_bf16_f32 v164, v148, v149
    v_cvt_pk_bf16_f32 v165, v150, v151
    v_cvt_pk_bf16_f32 v166, v152, v153
    v_cvt_pk_bf16_f32 v167, v154, v155
    s_mov_b32 s29, 3072
    buffer_store_dwordx4 v[160:163], v8, s[8:11], s29 offen sc1
    buffer_store_dwordx4 v[164:167], v8, s[8:11], s29 offen offset:512 sc1
    s_waitcnt vmcnt(10)
    v_mfma_f32_32x32x16_bf16 v[140:155], v[204:207], v[52:55], 0
    s_waitcnt vmcnt(9)
    v_mfma_f32_32x32x16_bf16 v[140:155], v[208:211], v[56:59], v[140:155]
    s_waitcnt vmcnt(8)
    v_mfma_f32_32x32x16_bf16 v[140:155], v[212:215], v[60:63], v[140:155]
    s_waitcnt vmcnt(7)
    v_mfma_f32_32x32x16_bf16 v[140:155], v[216:219], v[64:67], v[140:155]
    s_waitcnt vmcnt(6)
    v_mfma_f32_32x32x16_bf16 v[140:155], v[220:223], v[68:71], v[140:155]
    s_waitcnt vmcnt(5)
    v_mfma_f32_32x32x16_bf16 v[140:155], v[224:227], v[72:75], v[140:155]
    s_waitcnt vmcnt(4)
    v_mfma_f32_32x32x16_bf16 v[140:155], v[228:231], v[76:79], v[140:155]
    s_waitcnt vmcnt(3)
    v_mfma_f32_32x32x16_bf16 v[140:155], v[232:235], v[80:83], v[140:155]
    s_waitcnt vmcnt(2)
    v_mfma_f32_32x32x16_bf16 v[140:155], v[236:239], v[84:87], v[140:155]
    s_nop 11
    v_cvt_pk_bf16_f32 v160, v140, v141
    v_cvt_pk_bf16_f32 v161, v142, v143
    v_cvt_pk_bf16_f32 v162, v144, v145
    v_cvt_pk_bf16_f32 v163, v146, v147
    s_mov_b32 s29, 4096
    buffer_store_dwordx4 v[160:163], v8, s[8:11], s29 offen sc1
    s_branch SP_FD
SP_STC:
    s_mov_b32 s28, 5120
    buffer_store_dwordx4 v[52:55], v8, s[8:11], s28 offen sc1
    buffer_store_dwordx4 v[56:59], v8, s[8:11], s28 offen offset:512 sc1
    s_mov_b32 s28, 6144
    buffer_store_dwordx4 v[60:63], v8, s[8:11], s28 offen sc1
    buffer_store_dwordx4 v[64:67], v8, s[8:11], s28 offen offset:512 sc1
    s_mov_b32 s28, 7168
    buffer_store_dwordx4 v[68:71], v8, s[8:11], s28 offen sc1
    buffer_store_dwordx4 v[72:75], v8, s[8:11], s28 offen offset:512 sc1
    s_mov_b32 s28, 8192
    buffer_store_dwordx4 v[76:79], v8, s[8:11], s28 offen sc1
    buffer_store_dwordx4 v[80:83], v8, s[8:11], s28 offen offset:512 sc1
    s_mov_b32 s28, 4608
    buffer_store_dwordx4 v[84:87], v8, s[8:11], s28 offen sc1
SP_FD:
    s_branch SP_END
SP_UP:
    s_load_dwordx2 s[4:5], s[0:1], 40
    s_sub_u32 s21, s20, 10
    s_mul_i32 s26, s21, 15
    v_and_b32 v2, 15, v0
    v_lshrrev_b32 v3, 4, v0
    v_mul_u32_u24 v5, 4608, v3
    v_lshl_add_u32 v5, v2, 1, v5
    v_lshlrev_b32 v6, 4, v0
    s_mov_b32 s21, 0
    s_mov_b32 s6, 82944
    s_mov_b32 s7, 0x00020000
SP_UPL:
    s_add_u32 s22, s26, s21
    s_mul_i32 s23, s22, 205
    s_lshr_b32 s23, s23, 10
    s_lshl_b32 s24, s23, 5
    s_waitcnt lgkmcnt(0)
    buffer_load_ushort v16, v5, s[4:7], s24 offen offset:0
    buffer_load_ushort v17, v5, s[4:7], s24 offen offset:576
    buffer_load_ushort v18, v5, s[4:7], s24 offen offset:1152
    buffer_load_ushort v19, v5, s[4:7], s24 offen offset:1728
    buffer_load_ushort v20, v5, s[4:7], s24 offen offset:2304
    buffer_load_ushort v21, v5, s[4:7], s24 offen offset:2880
    buffer_load_ushort v22, v5, s[4:7], s24 offen offset:3456
    buffer_load_ushort v23, v5, s[4:7], s24 offen offset:4032
    s_add_u32 s24, s24, 18432
    buffer_load_ushort v24, v5, s[4:7], s24 offen offset:0
    buffer_load_ushort v25, v5, s[4:7], s24 offen offset:576
    buffer_load_ushort v26, v5, s[4:7], s24 offen offset:1152
    buffer_load_ushort v27, v5, s[4:7], s24 offen offset:1728
    buffer_load_ushort v28, v5, s[4:7], s24 offen offset:2304
    buffer_load_ushort v29, v5, s[4:7], s24 offen offset:2880
    buffer_load_ushort v30, v5, s[4:7], s24 offen offset:3456
    buffer_load_ushort v31, v5, s[4:7], s24 offen offset:4032
    s_add_u32 s24, s24, 18432
    buffer_load_ushort v32, v5, s[4:7], s24 offen offset:0
    buffer_load_ushort v33, v5, s[4:7], s24 offen offset:576
    buffer_load_ushort v34, v5, s[4:7], s24 offen offset:1152
    buffer_load_ushort v35, v5, s[4:7], s24 offen offset:1728
    buffer_load_ushort v36, v5, s[4:7], s24 offen offset:2304
    buffer_load_ushort v37, v5, s[4:7], s24 offen offset:2880
    buffer_load_ushort v38, v5, s[4:7], s24 offen offset:3456
    buffer_load_ushort v39, v5, s[4:7], s24 offen offset:4032
    s_add_u32 s24, s24, 18432
    buffer_load_ushort v40, v5, s[4:7], s24 offen offset:0
    buffer_load_ushort v41, v5, s[4:7], s24 offen offset:576
    buffer_load_ushort v42, v5, s[4:7], s24 offen offset:1152
    buffer_load_ushort v43, v5, s[4:7], s24 offen offset:1728
    buffer_load_ushort v44, v5, s[4:7], s24 offen offset:2304
    buffer_load_ushort v45, v5, s[4:7], s24 offen offset:2880
    buffer_load_ushort v46, v5, s[4:7], s24 offen offset:3456
    buffer_load_ushort v47, v5, s[4:7], s24 offen offset:4032
    s_add_u32 s24, s24, 18432
    buffer_load_ushort v48, v5, s[4:7], s24 offen offset:0
    buffer_load_ushort v49, v5, s[4:7], s24 offen offset:576
    buffer_load_ushort v50, v5, s[4:7], s24 offen offset:1152
    buffer_load_ushort v51, v5, s[4:7], s24 offen offset:1728
    buffer_load_ushort v52, v5, s[4:7], s24 offen offset:2304
    buffer_load_ushort v53, v5, s[4:7], s24 offen offset:2880
    buffer_load_ushort v54, v5, s[4:7], s24 offen offset:3456
    buffer_load_ushort v55, v5, s[4:7], s24 offen offset:4032
    s_lshl_b32 s22, s22, 10
    s_add_u32 s22, s22, 2686976
    s_waitcnt vmcnt(38)
    v_lshl_or_b32 v60, v17, 16, v16
    s_waitcnt vmcnt(36)
    v_lshl_or_b32 v61, v19, 16, v18
    s_waitcnt vmcnt(34)
    v_lshl_or_b32 v62, v21, 16, v20
    s_waitcnt vmcnt(32)
    v_lshl_or_b32 v63, v23, 16, v22
    buffer_store_dwordx4 v[60:63], v6, s[8:11], s22 offen sc1
    s_add_u32 s22, s22, 1024
    s_waitcnt vmcnt(31)
    v_lshl_or_b32 v64, v25, 16, v24
    s_waitcnt vmcnt(29)
    v_lshl_or_b32 v65, v27, 16, v26
    s_waitcnt vmcnt(27)
    v_lshl_or_b32 v66, v29, 16, v28
    s_waitcnt vmcnt(25)
    v_lshl_or_b32 v67, v31, 16, v30
    buffer_store_dwordx4 v[64:67], v6, s[8:11], s22 offen sc1
    s_add_u32 s22, s22, 1024
    s_waitcnt vmcnt(24)
    v_lshl_or_b32 v68, v33, 16, v32
    s_waitcnt vmcnt(22)
    v_lshl_or_b32 v69, v35, 16, v34
    s_waitcnt vmcnt(20)
    v_lshl_or_b32 v70, v37, 16, v36
    s_waitcnt vmcnt(18)
    v_lshl_or_b32 v71, v39, 16, v38
    buffer_store_dwordx4 v[68:71], v6, s[8:11], s22 offen sc1
    s_add_u32 s22, s22, 1024
    s_waitcnt vmcnt(17)
    v_lshl_or_b32 v72, v41, 16, v40
    s_waitcnt vmcnt(15)
    v_lshl_or_b32 v73, v43, 16, v42
    s_waitcnt vmcnt(13)
    v_lshl_or_b32 v74, v45, 16, v44
    s_waitcnt vmcnt(11)
    v_lshl_or_b32 v75, v47, 16, v46
    buffer_store_dwordx4 v[72:75], v6, s[8:11], s22 offen sc1
    s_add_u32 s22, s22, 1024
    s_waitcnt vmcnt(10)
    v_lshl_or_b32 v76, v49, 16, v48
    s_waitcnt vmcnt(8)
    v_lshl_or_b32 v77, v51, 16, v50
    s_waitcnt vmcnt(6)
    v_lshl_or_b32 v78, v53, 16, v52
    s_waitcnt vmcnt(4)
    v_lshl_or_b32 v79, v55, 16, v54
    buffer_store_dwordx4 v[76:79], v6, s[8:11], s22 offen sc1
    s_add_u32 s21, s21, 5
    s_cmp_lt_u32 s21, 15
    s_cbranch_scc1 SP_UPL
    s_load_dwordx2 s[4:5], s[0:1], 48
    s_sub_u32 s21, s20, 10
    s_mov_b32 s6, 4320
    v_lshrrev_b32 v2, 2, v0
    v_and_b32 v3, 3, v0
    v_add_u32 v3, 1, v3
    v_mul_u32_u24 v3, 288, v3
    v_lshlrev_b32 v2, 1, v2
    v_sub_u32 v2, v2, v3
    v_mul_u32_u24 v6, 40, v0
SP_TWL:
    s_lshl_b32 s22, s21, 5
    v_add_u32 v5, s22, v2
    v_add_u32 v40, 0, v5
    s_waitcnt lgkmcnt(0)
    buffer_load_ushort v16, v40, s[4:7], 0 offen
    v_add_u32 v41, 288, v5
    buffer_load_ushort v17, v41, s[4:7], 0 offen
    v_add_u32 v42, 576, v5
    buffer_load_ushort v18, v42, s[4:7], 0 offen
    v_add_u32 v43, 864, v5
    buffer_load_ushort v19, v43, s[4:7], 0 offen
    v_add_u32 v44, 1152, v5
    buffer_load_ushort v20, v44, s[4:7], 0 offen
    v_add_u32 v45, 1440, v5
    buffer_load_ushort v21, v45, s[4:7], 0 offen
    v_add_u32 v46, 1728, v5
    buffer_load_ushort v22, v46, s[4:7], 0 offen
    v_add_u32 v47, 2016, v5
    buffer_load_ushort v23, v47, s[4:7], 0 offen
    v_add_u32 v48, 2304, v5
    buffer_load_ushort v24, v48, s[4:7], 0 offen
    v_add_u32 v49, 2592, v5
    buffer_load_ushort v25, v49, s[4:7], 0 offen
    v_add_u32 v50, 2880, v5
    buffer_load_ushort v26, v50, s[4:7], 0 offen
    v_add_u32 v51, 3168, v5
    buffer_load_ushort v27, v51, s[4:7], 0 offen
    v_add_u32 v52, 3456, v5
    buffer_load_ushort v28, v52, s[4:7], 0 offen
    v_add_u32 v53, 3744, v5
    buffer_load_ushort v29, v53, s[4:7], 0 offen
    v_add_u32 v54, 4032, v5
    buffer_load_ushort v30, v54, s[4:7], 0 offen
    v_add_u32 v55, 4320, v5
    buffer_load_ushort v31, v55, s[4:7], 0 offen
    v_add_u32 v56, 4608, v5
    buffer_load_ushort v32, v56, s[4:7], 0 offen
    v_add_u32 v57, 4896, v5
    buffer_load_ushort v33, v57, s[4:7], 0 offen
    v_add_u32 v58, 5184, v5
    buffer_load_ushort v34, v58, s[4:7], 0 offen
    v_add_u32 v59, 5472, v5
    buffer_load_ushort v35, v59, s[4:7], 0 offen
    s_waitcnt vmcnt(18)
    v_lshl_or_b32 v60, v17, 16, v16
    s_waitcnt vmcnt(16)
    v_lshl_or_b32 v61, v19, 16, v18
    s_waitcnt vmcnt(14)
    v_lshl_or_b32 v62, v21, 16, v20
    s_waitcnt vmcnt(12)
    v_lshl_or_b32 v63, v23, 16, v22
    s_waitcnt vmcnt(10)
    v_lshl_or_b32 v64, v25, 16, v24
    s_waitcnt vmcnt(8)
    v_lshl_or_b32 v65, v27, 16, v26
    s_waitcnt vmcnt(6)
    v_lshl_or_b32 v66, v29, 16, v28
    s_waitcnt vmcnt(4)
    v_lshl_or_b32 v67, v31, 16, v30
    s_waitcnt vmcnt(2)
    v_lshl_or_b32 v68, v33, 16, v32
    s_waitcnt vmcnt(0)
    v_lshl_or_b32 v69, v35, 16, v34
    s_mul_i32 s22, s21, 2560
    s_add_u32 s22, s22, 2785280
    buffer_store_dwordx4 v[60:63], v6, s[8:11], s22 offen sc1
    buffer_store_dwordx4 v[64:67], v6, s[8:11], s22 offen offset:16 sc1
    buffer_store_dwordx2 v[68:69], v6, s[8:11], s22 offen offset:32 sc1
    s_add_u32 s21, s21, 6
    s_cmp_lt_u32 s21, 9
    s_cbranch_scc1 SP_TWL
SP_END:
    s_waitcnt vmcnt(0)
    v_mov_b32 v15, 0
    s_mov_b32 s65, 0
POLL0:
    buffer_load_dword v200, v15, s[52:55], 0 offen sc1
POLLC0:
    s_waitcnt vmcnt(0)
    v_cmp_eq_u32 vcc, 0, v200
    s_add_u32 s65, s65, 1
    s_nop 3
    s_cbranch_vccz POLLD0
    s_sleep 1
    s_cmp_lt_u32 s65, 65536
    s_cbranch_scc1 POLL0
POLLD0:
    v_readfirstlane_b32 s64, v200
    s_lshl_b32 s3, s20, 6
    s_add_u32 s3, s3, 8585216
    v_mov_b32 v13, s3
    v_mov_b32 v14, s64
    s_mov_b64 exec, 1
    buffer_store_dword v14, v13, s[8:11], 0 offen sc1
    s_endpgm
K_LAST:
    s_endpgm
.section .rodata,"a"
.p2align 6
.amdhsa_kernel standalone__conformer_family_branchformer__speech_kernel
  .amdhsa_next_free_vgpr 512
  .amdhsa_next_free_sgpr 100
  .amdhsa_accum_offset 256
  .amdhsa_group_segment_fixed_size 0
  .amdhsa_kernarg_size 96
  .amdhsa_user_sgpr_count 2
  .amdhsa_user_sgpr_kernarg_segment_ptr 1
  .amdhsa_system_sgpr_workgroup_id_x 1
  .amdhsa_float_denorm_mode_32 3
.end_amdhsa_kernel
```
